```python
import torch

def _softmax(x, axis=-1):
    return torch.softmax(x, dim=axis)
def _gelu(x):
    return torch.nn.functional.gelu(x, approximate="tanh")
def _silu(x):
    return torch.nn.functional.silu(x)
def _sigmoid(x):
    return torch.sigmoid(x)
def _layernorm(x, axis=-1, eps=1e-5):
    m = x.mean(dim=axis, keepdim=True)
    v = x.var(dim=axis, keepdim=True, unbiased=False)
    return (x - m) / torch.sqrt(v + eps)
def _scatter_add(tgt, idx, src, axis=0):
    return tgt.clone().index_add_(axis, idx, src)
def _segment_sum(src, seg, n):
    out = torch.zeros((n,) + src.shape[1:], dtype=src.dtype)
    return out.index_add_(0, seg, src)
def _pad(x, pw):
    flat = tuple(v for pair in reversed(pw) for v in pair)
    return torch.nn.functional.pad(x, flat)

kernel_name = 'standalone__edge_featured_mpnn_egc__graph'

def setup_inputs():

    _w = (lambda a: (lambda t: t.to(torch.bfloat16) if t.is_floating_point() else t)(torch.as_tensor(a)))
    N, deg, D, De = 10000, 32, 128, max(4, 1)
    E = N * deg
    return {
        "x": _w((lambda *s: torch.randn(*s, dtype=torch.bfloat16) * 0.1)(N, D)),
        "e_attr": _w((lambda *s: torch.randn(*s, dtype=torch.bfloat16) * 0.1)(E, De)),
        "src": _w((lambda lo, hi, *s: torch.randint(lo, hi, s))(0, N, E).to(torch.int64)),
        "dst": _w((lambda lo, hi, *s: torch.randint(lo, hi, s))(0, N, E).to(torch.int64)),
        "u_w": _w((lambda *s: torch.randn(*s, dtype=torch.bfloat16) * 0.05)(D, D)),
        "v_w": _w((lambda *s: torch.randn(*s, dtype=torch.bfloat16) * 0.05)(D, D)),
        "g_w": _w((lambda *s: torch.randn(*s, dtype=torch.bfloat16) * 0.1)(2 * D + De, D)),
    }

def reference(x, e_attr, src, dst, u_w, v_w, g_w):
    N, D = x.shape
    g_in = torch.concatenate([x[dst], x[src], e_attr], axis=-1)
    eta = _sigmoid(g_in @ g_w)
    hv = x @ v_w
    msg = eta * hv[src]
    agg = _segment_sum(msg, dst, N)
    return _silu(x @ u_w + agg)
```

```asm
; @launch grid=(256,1,1) block=(1024,1,1) lds=152320
.amdgcn_target "amdgcn-amd-amdhsa--gfx950"
.text
.globl standalone__edge_featured_mpnn_egc__graph_kernel
.p2align 8
.type standalone__edge_featured_mpnn_egc__graph_kernel,@function
standalone__edge_featured_mpnn_egc__graph_kernel:
    s_load_dwordx16 s[4:19], s[0:1], 0
    s_load_dwordx4 s[20:23], s[0:1], 64
    s_lshr_b32 s69, s2, 3
    s_getpc_b64 s[54:55]
L_PC:
    s_mul_i32 s57, s69, 384
    v_lshl_add_u32 v6, v0, 7, s57
    v_cmp_gt_u32 vcc, 3, v0
    v_min_u32 v6, L_END-L_PC, v6
    s_cbranch_vccz L_NOCW
    v_mov_b32 v7, 0
    v_lshl_add_u64 v[6:7], v[6:7], 0, s[54:55]
    s_mov_b64 exec, vcc
    global_load_dword v9, v[6:7], off
    s_mov_b64 exec, -1
L_NOCW:
    s_and_b32 s54, s2, 3
    s_lshl_b32 s54, s54, 5
    s_add_u32 s69, s69, s54
    s_mul_i32 s101, s69, 625
    s_add_u32 s101, s101, 7
    s_lshr_b32 s101, s101, 3
    s_lshl_b32 s101, s101, 8
    s_cmp_ge_u32 s2, 256
    s_cbranch_scc1 L_END
    v_lshrrev_b32 v4, 6, v0
    v_and_b32 v1, 63, v0
    v_readfirstlane_b32 s59, v4
    s_bfe_u32 s54, s2, 0x10002
    s_lshl_b32 s68, s54, 7
    s_add_u32 s70, s68, s69
    s_sub_u32 s3, s59, 5
    s_cmp_lt_u32 s3, 5
    s_cbranch_scc0 L_NOBIN
    s_mul_i32 s55, s70, 5000
    s_mul_i32 s56, s3, 1000
    s_add_u32 s55, s55, s56
    v_lshl_add_u32 v20, v1, 3, s55
    v_lshlrev_b32 v21, 1, v20
    s_setprio 3
    s_mov_b32 s51, 1
    s_waitcnt lgkmcnt(0)
    global_load_dwordx2 v[4:5], v20, s[10:11]
    s_mov_b32 exec_hi, 0x1fffffff
    global_load_dwordx2 v[6:7], v20, s[10:11] offset:512
    s_barrier
    global_load_dwordx2 v[10:11], v20, s[8:9] offset:512 nt
    s_mov_b32 exec_hi, -1
    global_load_dwordx2 v[8:9], v20, s[8:9] nt
    global_load_dwordx4 v[12:15], v21, s[6:7] nt
    s_mov_b32 exec_hi, 0x1fffffff
    global_load_dwordx4 v[16:19], v21, s[6:7] offset:1024 nt
    s_mov_b32 exec_hi, -1
    s_mul_i32 s54, s70, 15360
    s_add_u32 s54, s54, 5242880
    s_add_u32 s32, s22, s54
    s_addc_u32 s33, s23, 0
    s_mov_b32 s34, 15104
    s_mov_b32 s35, 0x20000
    s_add_u32 s56, s22, 11010048
    s_addc_u32 s57, s23, 0
    s_load_dword s71, s[56:57], 0
L_SETUP:
    s_and_b32 s52, s59, 3
    s_cmp_ge_u32 s59, 12
    s_cselect_b32 s54, 32768, 0
    s_add_u32 s54, s54, 66304
    s_mov_b32 s55, 131840
    v_lshrrev_b32 v40, 4, v1
    v_bfe_u32 v41, v1, 2, 2
    v_and_b32 v42, 3, v1
    v_and_b32 v102, 15, v1
    v_lshlrev_b32 v43, 10, v40
    v_lshlrev_b32 v44, 7, v41
    v_lshl_add_u32 v44, v42, 3, v44
    v_bfe_u32 v45, v1, 3, 2
    v_xor_b32 v45, s52, v45
    v_lshl_add_u32 v45, v45, 5, v44
    v_add3_u32 v100, v43, v45, s54
    s_lshl_b32 s54, s52, 2
    v_add_u32 v101, s54, v40
    v_xor_b32 v43, v102, v40
    v_lshlrev_b32 v43, 4, v43
    v_lshlrev_b32 v44, 8, v102
    v_add3_u32 v96, v43, v44, s55
    v_xor_b32 v97, 64, v96
    v_xor_b32 v98, 0x80, v96
    v_xor_b32 v99, 0xc0, v96
    s_mov_b32 s54, 65792
    v_lshl_add_u32 v105, v1, 3, s54
    v_cmp_eq_u32 vcc, v40, v41
    v_mov_b32 v43, 0x3f80
    v_cmp_eq_u32 s[66:67], v40, v42
    v_cndmask_b32 v108, 0, v43, vcc
    v_mov_b32 v109, 0
    v_lshlrev_b32 v42, 4, v42
    v_lshlrev_b64 v[108:109], v42, v[108:109]
    v_mov_b64 v[110:111], 0
    v_mov_b64 v[112:113], v[108:109]
    v_mov_b64 v[114:115], 0
    v_mov_b64 v[116:117], v[108:109]
    v_mov_b64 v[118:119], 0
    v_mov_b64 v[120:121], v[108:109]
    v_mov_b64 v[122:123], 0
    v_lshlrev_b32 v2, 4, v102
    v_lshlrev_b32 v3, 3, v102
    v_add_u32 v3, 21760, v3
    v_lshrrev_b32 v40, 2, v0
    s_lshl_b32 s54, s69, 3
    v_lshl_add_u32 v103, v40, 10, s54
    v_mul_u32_u24 v126, 15360, v40
    v_mov_b32 v124, 65024
    v_mov_b32 v125, 1
    s_and_b32 s54, s69, 7
    s_cmp_eq_u32 s54, 0
    s_addc_u32 s1, 78, 0
    s_mov_b32 s75, 0xbfb8aa3b
    s_mov_b32 s62, 0x3f880000
    s_mov_b32 s63, 0x40040000
    s_mov_b32 s60, 512
    s_mov_b32 s61, 512
    s_mov_b32 s64, 0x67800000
    s_mov_b32 s53, 1
    s_mov_b32 s74, 4194304
    s_mul_i32 s55, s68, 20000
    s_add_u32 s24, s22, s55
    s_addc_u32 s25, s23, 0
    s_mov_b32 s26, 2560000
    s_mov_b32 s27, 0x20000
    s_add_u32 s28, s22, 5242880
    s_addc_u32 s29, s23, 0
    s_mov_b32 s30, 3932160
    s_mov_b32 s31, 0x20000
    s_cmp_eq_u32 s51, 0
    s_cbranch_scc1 L_STG
    s_mov_b32 s54, 429497
    s_mov_b32 s55, 625
    v_lshlrev_b32 v33, 3, v1
    s_mul_i32 s56, s3, 3072
    v_lshl_add_u32 v32, v1, 4, s56
    s_waitcnt vmcnt(4)
    v_mul_u32_u24 v24, s54, v4
    v_lshrrev_b32 v24, 25, v24
    v_lshlrev_b32 v20, 2, v24
    ds_add_rtn_u32 v28, v20, v125 offset:64000
    v_mul_u32_u24 v25, s54, v5
    v_lshrrev_b32 v25, 25, v25
    v_lshlrev_b32 v21, 2, v25
    ds_add_rtn_u32 v29, v21, v125 offset:64000
    s_mov_b32 exec_hi, 0x1fffffff
    v_mul_u32_u24 v26, s54, v6
    v_lshrrev_b32 v26, 25, v26
    v_lshlrev_b32 v22, 2, v26
    ds_add_rtn_u32 v30, v22, v125 offset:64000
    v_mul_u32_u24 v27, s54, v7
    v_lshrrev_b32 v27, 25, v27
    v_lshlrev_b32 v23, 2, v27
    ds_add_rtn_u32 v31, v23, v125 offset:64000
    s_mov_b64 exec, 1
    ds_add_u32 v124, v125 offset:12
    s_mov_b64 exec, -1
    v_mad_u32_u24 v24, v24, s55, 7
    v_lshrrev_b32 v24, 3, v24
    v_sub_u32 v24, v4, v24
    v_mad_u32_u24 v25, v25, s55, 7
    v_lshrrev_b32 v25, 3, v25
    v_sub_u32 v25, v5, v25
    v_mad_u32_u24 v26, v26, s55, 7
    v_lshrrev_b32 v26, 3, v26
    v_sub_u32 v26, v6, v26
    v_mad_u32_u24 v27, v27, s55, 7
    v_lshrrev_b32 v27, 3, v27
    v_sub_u32 v27, v7, v27
    s_mov_b64 exec, 1
L_BS1:
    s_sub_u32 s74, s74, 1
    s_cbranch_scc1 L_END
    ds_read_b32 v7, v124 offset:12
    s_waitcnt lgkmcnt(0)
    v_cmp_gt_u32 vcc, 5, v7
    s_cbranch_vccnz L_BS1
    s_mov_b64 exec, -1
    ds_read_b64 v[34:35], v33 offset:64000
    s_add_u32 s71, s71, 1
    s_xor_b32 s73, s71, 0x2545F491
    s_mul_i32 s72, s73, 0x9E3779B1
    s_mul_i32 s73, s73, 0x85EBCA6B
    s_lshr_b32 s100, s73, 25
    s_waitcnt lgkmcnt(0)
    v_add_u32 v36, v34, v35
    v_mov_b32 v37, v36
    s_nop 1
    v_add_u32_dpp v37, v37, v37 row_shr:1 row_mask:0xf bank_mask:0xf
    s_nop 1
    v_add_u32_dpp v37, v37, v37 row_shr:2 row_mask:0xf bank_mask:0xf
    s_nop 1
    v_add_u32_dpp v37, v37, v37 row_shr:4 row_mask:0xf bank_mask:0xf
    s_nop 1
    v_add_u32_dpp v37, v37, v37 row_shr:8 row_mask:0xf bank_mask:0xf
    s_nop 1
    v_add_u32_dpp v37, v37, v37 row_bcast:15 row_mask:0xa bank_mask:0xf
    s_nop 1
    v_add_u32_dpp v37, v37, v37 row_bcast:31 row_mask:0xc bank_mask:0xf
    v_sub_u32 v38, v37, v36
    v_add_u32 v39, v38, v34
    v_mul_u32_u24 v38, 12, v38
    v_mul_u32_u24 v39, 12, v39
    ds_write_b64 v33, v[38:39] offset:65280
    ds_read_b32 v20, v20 offset:65280
    ds_read_b32 v21, v21 offset:65280
    s_mov_b32 exec_hi, 0x1fffffff
    ds_read_b32 v22, v22 offset:65280
    ds_read_b32 v23, v23 offset:65280
    s_mov_b32 exec_hi, -1
    s_lshl_b32 s54, s100, 25
    s_lshl_b32 s55, s70, 10
    s_add_u32 s55, s55, 10485760
    v_lshl_or_b32 v48, v34, 14, v38
    v_lshl_or_b32 v50, v35, 14, v39
    v_or_b32 v48, s54, v48
    v_or_b32 v50, s54, v50
    v_mov_b32 v49, s72
    v_mov_b32 v51, s72
    v_lshl_add_u32 v52, v1, 4, s55
    s_waitcnt vmcnt(2) lgkmcnt(0)
    v_mad_u32_u24 v20, v28, 12, v20
    v_lshl_or_b32 v24, v8, 8, v24
    ds_write_b32 v20, v24 offset:8
    v_mad_u32_u24 v21, v29, 12, v21
    v_lshl_or_b32 v25, v9, 8, v25
    ds_write_b32 v21, v25 offset:8
    s_mov_b32 exec_hi, 0x1fffffff
    v_mad_u32_u24 v22, v30, 12, v22
    v_lshl_or_b32 v26, v10, 8, v26
    ds_write_b32 v22, v26 offset:8
    v_mad_u32_u24 v23, v31, 12, v23
    v_lshl_or_b32 v27, v11, 8, v27
    ds_write_b32 v23, v27 offset:8
    s_mov_b32 exec_hi, -1
    s_waitcnt vmcnt(1)
    ds_write2_b32 v20, v12, v13 offset0:0 offset1:1
    ds_write2_b32 v21, v14, v15 offset0:0 offset1:1
    s_mov_b32 exec_hi, 0x1fffffff
    s_waitcnt vmcnt(0)
    ds_write2_b32 v22, v16, v17 offset0:0 offset1:1
    ds_write2_b32 v23, v18, v19 offset0:0 offset1:1
    s_mov_b64 exec, 1
    ds_add_u32 v124, v125 offset:12
L_BS2:
    s_sub_u32 s74, s74, 1
    s_cbranch_scc1 L_END
    ds_read_b32 v7, v124 offset:12
    s_waitcnt lgkmcnt(0)
    v_cmp_gt_u32 vcc, 10, v7
    s_cbranch_vccnz L_BS2
    s_mov_b64 exec, -1
    ds_read_b128 v[8:11], v32 offset:0
    ds_read_b128 v[12:15], v32 offset:1024
    ds_read_b128 v[16:19], v32 offset:2048
    s_waitcnt lgkmcnt(2)
    buffer_store_dwordx4 v[8:11], v32, s[32:35], 0 offen offset:0 sc1
    s_waitcnt lgkmcnt(1)
    buffer_store_dwordx4 v[12:15], v32, s[32:35], 0 offen offset:1024 sc1
    s_waitcnt lgkmcnt(0)
    buffer_store_dwordx4 v[16:19], v32, s[32:35], 0 offen offset:2048 sc1
    s_mov_b64 exec, 1
    s_waitcnt vmcnt(0)
    ds_add_rtn_u32 v7, v124, v125 offset:24
    s_waitcnt lgkmcnt(0)
    v_cmp_eq_u32 vcc, 4, v7
    s_mov_b64 exec, -1
    s_cbranch_vccz L_NOPUB
    global_store_dwordx4 v52, v[48:51], s[22:23] sc1
L_NOPUB:
    s_setprio 0
    v_mov_b32 v4, s71
    ds_write_b32 v124, v4 offset:20
    s_cmp_eq_u32 s59, 5
    s_cbranch_scc0 L_GD
    s_lshl_b32 s56, s70, 7
    s_add_u32 s56, s56, 10747904
    v_mov_b32 v8, s56
    v_mov_b32 v10, s72
    v_mov_b32 v11, s73
    s_add_u32 s32, s22, 10485760
    s_addc_u32 s33, s23, 0
    s_mov_b32 s34, 262144
    s_mov_b32 s35, 0x20000
    s_mov_b64 exec, 1
    s_waitcnt lgkmcnt(0)
    s_barrier
    global_store_dwordx2 v8, v[10:11], s[22:23] sc1
    s_mov_b64 exec, -1
    s_branch L_TSD
L_NOBIN:
    s_mov_b32 s51, 0
    s_cmp_lt_u32 s59, 10
    s_cbranch_scc1 L_B1
    s_cmp_eq_u32 s59, 15
    s_cbranch_scc1 L_WARM
    v_lshlrev_b32 v12, 2, v0
    v_lshrrev_b32 v16, 2, v0
    v_subrev_u32 v16, 226, v16
    v_min_u32 v16, 31, v16
    v_mov_b32 v15, 0x249
    v_bfe_u32 v13, v15, v16, 1
    v_lshlrev_b32 v13, 22, v13
    ds_write_b32 v12, v13 offset:61440
    s_branch L_B1
L_WARM:
    s_lshr_b32 s56, s2, 3
    s_mul_i32 s56, s56, 9
    v_add_u32 v6, s56, v1
    v_min_u32 v8, 259, v6
    v_lshl_add_u32 v8, v8, 8, s68
    s_lshr_b32 s56, s56, 1
    v_add_u32 v6, s56, v1
    v_min_u32 v6, 127, v6
    v_lshl_add_u32 v6, v6, 8, s68
    v_lshrrev_b32 v4, 4, v1
    v_and_b32 v5, 15, v1
    v_lshl_add_u32 v4, v5, 2, v4
    s_add_u32 s56, s68, 65536
    v_lshl_add_u32 v4, v4, 1, s56
    s_waitcnt lgkmcnt(0)
    s_mov_b64 exec, 0x1ff
    global_load_dword v9, v8, s[16:17]
    s_mov_b64 exec, 31
    global_load_dword v9, v6, s[14:15]
    global_load_dword v9, v6, s[12:13]
    s_mov_b64 exec, -1
    global_load_short_d16_hi v10, v4, s[16:17]
    global_load_short_d16_hi v11, v4, s[16:17] offset:256
    global_load_short_d16_hi v12, v4, s[16:17] offset:512
    global_load_short_d16_hi v13, v4, s[16:17] offset:768
L_B1:
    s_waitcnt lgkmcnt(0)
    s_barrier
    s_mov_b32 s3, s59
    s_cmp_lt_u32 s59, 2
    s_cbranch_scc1 L_XL
    s_cmp_lt_u32 s59, 5
    s_cselect_b32 s3, 2, 7
    s_sub_u32 s3, s59, s3
    v_lshrrev_b32 v26, 3, v1
    v_lshlrev_b32 v26, 8, v26
    v_and_b32 v28, 7, v1
    v_lshlrev_b32 v28, 4, v28
    v_and_b32 v27, 16, v1
    v_lshlrev_b32 v27, 1, v27
    v_xor_b32 v28, v28, v27
    v_add3_u32 v26, v26, v28, s68
    v_xor_b32 v27, 64, v26
    s_add_u32 s32, s16, 32768
    s_addc_u32 s33, s17, 0
    s_cmp_ge_u32 s3, 2
    s_cselect_b64 s[32:33], s[14:15], s[32:33]
    s_cmp_ge_u32 s3, 4
    s_cselect_b64 s[32:33], s[16:17], s[32:33]
    s_cmp_ge_u32 s3, 6
    s_cselect_b64 s[32:33], s[12:13], s[32:33]
    s_mov_b32 s34, 32768
    s_mov_b32 s35, 0x20000
    s_cmp_ge_u32 s3, 4
    s_cbranch_scc1 L_SETUP
    s_and_b32 s54, s3, 1
    s_lshl_b32 s54, s54, 14
    s_lshl_b32 s55, s3, 13
    s_add_u32 s55, s55, 66304
    s_mov_b32 s56, 4
L_WL:
    s_mov_b32 m0, s55
    s_add_u32 s57, s54, 1024
    buffer_load_dwordx4 v26, s[32:35], s54 offen lds
    buffer_load_dwordx4 v27, s[32:35], s57 offen offset:1024 lds
    s_add_u32 s54, s54, 4096
    s_add_u32 s55, s55, 2048
    s_sub_u32 s56, s56, 1
    s_cmp_lg_u32 s56, 0
    s_cbranch_scc1 L_WL
    s_branch L_SETUP
L_XL:
    v_lshrrev_b32 v4, 4, v1
    v_and_b32 v5, 15, v1
    v_xor_b32 v5, v5, v4
    v_lshlrev_b32 v5, 4, v5
    s_lshl_b32 s55, s3, 7
    v_xor_b32 v5, s55, v5
    s_mul_i32 s54, s3, 10240
    s_add_u32 s56, s101, s54
    s_sub_u32 s57, 2560000, s56
    v_lshl_add_u32 v4, v4, 8, v5
    s_add_u32 s55, s54, 131840
    v_xor_b32 v5, 64, v4
    v_xor_b32 v6, 0x80, v4
    v_xor_b32 v7, 0xc0, v4
    v_mov_b32 v26, 0
    v_mov_b32 v27, 0
    s_add_u32 s32, s4, s56
    s_addc_u32 s33, s5, 0
    s_mov_b32 s34, s57
    s_mov_b32 s35, 0x20000
    s_mov_b32 s54, 0
    s_mov_b32 s3, 0
    s_mov_b32 m0, s55
    s_add_u32 s55, s55, 4096
    buffer_load_dwordx4 v4, s[32:35], s54 offen offset:0  lds
    buffer_load_dwordx4 v5, s[32:35], s54 offen offset:1024  lds
    buffer_load_dwordx4 v6, s[32:35], s54 offen offset:2048  lds
    buffer_load_dwordx4 v7, s[32:35], s54 offen offset:3072  lds
    s_add_u32 s54, s54, 4096
    s_mov_b32 m0, s55
    s_add_u32 s55, s55, 4096
    buffer_load_dwordx4 v4, s[32:35], s54 offen offset:0  lds
    buffer_load_dwordx4 v5, s[32:35], s54 offen offset:1024  lds
    buffer_load_dwordx4 v6, s[32:35], s54 offen offset:2048  lds
    buffer_load_dwordx4 v7, s[32:35], s54 offen offset:3072  lds
    s_add_u32 s54, s54, 4096
    s_mov_b32 m0, s55
    s_add_u32 s55, s55, 4096
    buffer_load_dwordx4 v4, s[32:35], s54 offen offset:0  lds
    buffer_load_dwordx4 v5, s[32:35], s54 offen offset:1024  lds
    s_branch L_SETUP
L_STG:
    v_mov_b32 v6, 1
    s_cmp_lt_u32 s3, 4
    s_cbranch_scc1 L_EARLY
    s_cmp_eq_u32 s3, 8
    s_cbranch_scc1 L_GC
    s_mov_b64 exec, 1
L_BS3:
    s_sub_u32 s74, s74, 1
    s_cbranch_scc1 L_END
    s_sleep 2
    ds_read_b32 v7, v124 offset:16
    s_waitcnt lgkmcnt(0)
    v_cmp_gt_u32 vcc, 3, v7
    s_cbranch_vccnz L_BS3
    s_mov_b64 exec, -1
    s_and_b32 s54, s3, 1
    s_lshl_b32 s54, s54, 14
    s_lshl_b32 s55, s3, 13
    s_add_u32 s55, s55, 66304
    s_mov_b32 s56, 4
L_WL2:
    s_mov_b32 m0, s55
    s_add_u32 s57, s54, 1024
    buffer_load_dwordx4 v26, s[32:35], s54 offen lds
    buffer_load_dwordx4 v27, s[32:35], s57 offen offset:1024 lds
    s_add_u32 s54, s54, 4096
    s_add_u32 s55, s55, 2048
    s_sub_u32 s56, s56, 1
    s_cmp_lg_u32 s56, 0
    s_cbranch_scc1 L_WL2
    v_mov_b32 v6, 0x100
L_EARLY:
    s_mov_b64 exec, 1
    s_waitcnt vmcnt(0)
    ds_add_u32 v124, v6 offset:16
    s_cmp_ge_u32 s59, 12
    s_cbranch_scc1 L_LAND2
    s_cmp_ge_u32 s59, 4
    s_cbranch_scc1 L_GD
L_LAND1:
    s_sub_u32 s74, s74, 1
    s_cbranch_scc1 L_END
    ds_read_b32 v7, v124 offset:16
    s_waitcnt lgkmcnt(0)
    v_and_b32 v7, 0xff, v7
    v_cmp_ne_u32 vcc, 6, v7
    s_cbranch_vccnz L_LAND1
    s_mov_b64 exec, -1
    s_setprio 2
    ds_read_b128 v[40:43], v96 offset:0
    ds_read_b64_tr_b16 v[8:9], v100 offset:0
    ds_read_b64_tr_b16 v[10:11], v100 offset:512
    ds_read_b64_tr_b16 v[24:25], v100 offset:16384
    ds_read_b64_tr_b16 v[26:27], v100 offset:16896
    ds_read_b128 v[44:47], v97 offset:0
    ds_read_b64_tr_b16 v[12:13], v100 offset:4096
    ds_read_b64_tr_b16 v[14:15], v100 offset:4608
    ds_read_b64_tr_b16 v[28:29], v100 offset:20480
    ds_read_b64_tr_b16 v[30:31], v100 offset:20992
    s_mov_b32 s54, s101
    s_lshl_b32 s56, s1, 2
    s_sub_u32 s56, 320, s56
    s_lshr_b32 s56, -1, s56
    v_lshrrev_b32 v6, 2, v1
    v_and_b32 v7, 3, v1
    s_lshl_b32 s55, s52, 6
    v_lshl_add_u32 v4, v6, 8, s55
    v_lshl_add_u32 v4, v7, 4, v4
    v_lshl_add_u32 v5, v7, 4, v6
    v_lshlrev_b32 v5, 2, v5
    s_mov_b32 s55, 0x07060302
    s_setreg_imm32_b32 hwreg(HW_REG_MODE, 4, 2), 0
    s_waitcnt lgkmcnt(4)
    ds_read_b128 v[48:51], v98 offset:0
    ds_read_b64_tr_b16 v[16:17], v100 offset:8192
    ds_read_b64_tr_b16 v[18:19], v100 offset:8704
    ds_read_b64_tr_b16 v[32:33], v100 offset:24576
    ds_read_b64_tr_b16 v[34:35], v100 offset:25088
    ds_read_b128 v[52:55], v99 offset:0
    ds_read_b64_tr_b16 v[20:21], v100 offset:12288
    ds_read_b64_tr_b16 v[22:23], v100 offset:12800
    ds_read_b64_tr_b16 v[36:37], v100 offset:28672
    ds_read_b64_tr_b16 v[38:39], v100 offset:29184
    s_waitcnt lgkmcnt(0)
    v_mfma_f32_16x16x32_bf16 v[72:75], v[8:11], v[40:43], 0
    ds_read_b128 v[56:59], v96 offset:4096
    v_mfma_f32_16x16x32_bf16 v[76:79], v[24:27], v[40:43], 0
    ds_read_b128 v[60:63], v97 offset:4096
    v_mfma_f32_16x16x32_bf16 v[72:75], v[12:15], v[44:47], v[72:75]
    ds_read_b128 v[64:67], v98 offset:4096
    v_mfma_f32_16x16x32_bf16 v[76:79], v[28:31], v[44:47], v[76:79]
    ds_read_b128 v[68:71], v99 offset:4096
    v_mfma_f32_16x16x32_bf16 v[72:75], v[16:19], v[48:51], v[72:75]
    v_mfma_f32_16x16x32_bf16 v[76:79], v[32:35], v[48:51], v[76:79]
    v_mfma_f32_16x16x32_bf16 v[72:75], v[20:23], v[52:55], v[72:75]
    v_mfma_f32_16x16x32_bf16 v[76:79], v[36:39], v[52:55], v[76:79]
    s_waitcnt lgkmcnt(0)
    v_mfma_f32_16x16x32_bf16 v[80:83], v[8:11], v[56:59], 0
    ds_read_b128 v[40:43], v96 offset:8192
    v_mfma_f32_16x16x32_bf16 v[84:87], v[24:27], v[56:59], 0
    ds_read_b128 v[44:47], v97 offset:8192
    v_mfma_f32_16x16x32_bf16 v[80:83], v[12:15], v[60:63], v[80:83]
    ds_read_b128 v[48:51], v98 offset:8192
    v_mfma_f32_16x16x32_bf16 v[84:87], v[28:31], v[60:63], v[84:87]
    ds_read_b128 v[52:55], v99 offset:8192
    v_mul_f32 v72, s75, v72
    v_mul_f32 v73, s75, v73
    v_mul_f32 v74, s75, v74
    v_mul_f32 v75, s75, v75
    v_add_f32 v76, 0, v76
    v_mfma_f32_16x16x32_bf16 v[80:83], v[16:19], v[64:67], v[80:83]
    v_add_f32 v77, 0, v77
    v_add_f32 v79, 0, v79
    v_add_u32 v78, 0x8000, v78
    v_add_u32 v76, 0x8000, v76
    v_add_u32 v79, 0x8000, v79
    v_mfma_f32_16x16x32_bf16 v[84:87], v[32:35], v[64:67], v[84:87]
    v_add_u32 v77, 0x8000, v77
    v_sub_u32_sdwa v76, v76, v78 clamp dst_sel:DWORD dst_unused:UNUSED_PAD src0_sel:DWORD src1_sel:WORD_1
    v_cvt_pk_bf16_f32 v90, v72, v73
    v_sub_u32_sdwa v79, v79, v76 clamp dst_sel:DWORD dst_unused:UNUSED_PAD src0_sel:DWORD src1_sel:WORD_1
    v_cvt_pk_bf16_f32 v91, v74, v75
    v_mfma_f32_16x16x32_bf16 v[80:83], v[20:23], v[68:71], v[80:83]
    v_sub_u32_sdwa v77, v77, v79 clamp dst_sel:DWORD dst_unused:UNUSED_PAD src0_sel:DWORD src1_sel:WORD_1
    v_perm_b32 v88, v76, v78, s55
    v_perm_b32 v89, v77, v79, s55
    ds_bpermute_b32 v90, v5, v90
    ds_bpermute_b32 v91, v5, v91
    v_mfma_f32_16x16x32_bf16 v[84:87], v[36:39], v[68:71], v[84:87]
    ds_bpermute_b32 v88, v5, v88
    ds_bpermute_b32 v89, v5, v89
    s_waitcnt lgkmcnt(4)
    v_mfma_f32_16x16x32_bf16 v[72:75], v[8:11], v[40:43], 0
    ds_read_b128 v[56:59], v96 offset:12288
    v_mfma_f32_16x16x32_bf16 v[76:79], v[24:27], v[40:43], 0
    ds_read_b128 v[60:63], v97 offset:12288
    v_mfma_f32_16x16x32_bf16 v[72:75], v[12:15], v[44:47], v[72:75]
    ds_read_b128 v[64:67], v98 offset:12288
    v_mfma_f32_16x16x32_bf16 v[76:79], v[28:31], v[44:47], v[76:79]
    ds_read_b128 v[68:71], v99 offset:12288
    s_waitcnt lgkmcnt(4)
    buffer_store_dwordx4 v[88:91], v4, s[24:27], s54 offen sc1
    s_add_u32 s54, s54, 4096
    v_mul_f32 v80, s75, v80
    v_mul_f32 v81, s75, v81
    v_mul_f32 v82, s75, v82
    v_mul_f32 v83, s75, v83
    v_add_f32 v84, 0, v84
    v_mfma_f32_16x16x32_bf16 v[72:75], v[16:19], v[48:51], v[72:75]
    v_add_f32 v85, 0, v85
    v_add_f32 v87, 0, v87
    v_add_u32 v86, 0x8000, v86
    v_add_u32 v84, 0x8000, v84
    v_add_u32 v87, 0x8000, v87
    v_mfma_f32_16x16x32_bf16 v[76:79], v[32:35], v[48:51], v[76:79]
    v_add_u32 v85, 0x8000, v85
    v_sub_u32_sdwa v84, v84, v86 clamp dst_sel:DWORD dst_unused:UNUSED_PAD src0_sel:DWORD src1_sel:WORD_1
    v_cvt_pk_bf16_f32 v94, v80, v81
    v_sub_u32_sdwa v87, v87, v84 clamp dst_sel:DWORD dst_unused:UNUSED_PAD src0_sel:DWORD src1_sel:WORD_1
    v_cvt_pk_bf16_f32 v95, v82, v83
    v_mfma_f32_16x16x32_bf16 v[72:75], v[20:23], v[52:55], v[72:75]
    v_sub_u32_sdwa v85, v85, v87 clamp dst_sel:DWORD dst_unused:UNUSED_PAD src0_sel:DWORD src1_sel:WORD_1
    v_perm_b32 v92, v84, v86, s55
    v_perm_b32 v93, v85, v87, s55
    ds_bpermute_b32 v94, v5, v94
    ds_bpermute_b32 v95, v5, v95
    v_mfma_f32_16x16x32_bf16 v[76:79], v[36:39], v[52:55], v[76:79]
    ds_bpermute_b32 v92, v5, v92
    ds_bpermute_b32 v93, v5, v93
    s_waitcnt lgkmcnt(4)
    v_mfma_f32_16x16x32_bf16 v[80:83], v[8:11], v[56:59], 0
    ds_read_b128 v[40:43], v96 offset:16384
    v_mfma_f32_16x16x32_bf16 v[84:87], v[24:27], v[56:59], 0
    ds_read_b128 v[44:47], v97 offset:16384
    v_mfma_f32_16x16x32_bf16 v[80:83], v[12:15], v[60:63], v[80:83]
    ds_read_b128 v[48:51], v98 offset:16384
    v_mfma_f32_16x16x32_bf16 v[84:87], v[28:31], v[60:63], v[84:87]
    ds_read_b128 v[52:55], v99 offset:16384
    s_waitcnt lgkmcnt(4)
    buffer_store_dwordx4 v[92:95], v4, s[24:27], s54 offen sc1
    s_add_u32 s54, s54, 4096
    v_mul_f32 v72, s75, v72
    v_mul_f32 v73, s75, v73
    v_mul_f32 v74, s75, v74
    v_mul_f32 v75, s75, v75
    v_add_f32 v76, 0, v76
    v_mfma_f32_16x16x32_bf16 v[80:83], v[16:19], v[64:67], v[80:83]
    v_add_f32 v77, 0, v77
    v_add_f32 v79, 0, v79
    v_add_u32 v78, 0x8000, v78
    v_add_u32 v76, 0x8000, v76
    v_add_u32 v79, 0x8000, v79
    v_mfma_f32_16x16x32_bf16 v[84:87], v[32:35], v[64:67], v[84:87]
    v_add_u32 v77, 0x8000, v77
    v_sub_u32_sdwa v76, v76, v78 clamp dst_sel:DWORD dst_unused:UNUSED_PAD src0_sel:DWORD src1_sel:WORD_1
    v_cvt_pk_bf16_f32 v90, v72, v73
    v_sub_u32_sdwa v79, v79, v76 clamp dst_sel:DWORD dst_unused:UNUSED_PAD src0_sel:DWORD src1_sel:WORD_1
    v_cvt_pk_bf16_f32 v91, v74, v75
    v_mfma_f32_16x16x32_bf16 v[80:83], v[20:23], v[68:71], v[80:83]
    v_sub_u32_sdwa v77, v77, v79 clamp dst_sel:DWORD dst_unused:UNUSED_PAD src0_sel:DWORD src1_sel:WORD_1
    v_perm_b32 v88, v76, v78, s55
    v_perm_b32 v89, v77, v79, s55
    ds_bpermute_b32 v90, v5, v90
    ds_bpermute_b32 v91, v5, v91
    v_mfma_f32_16x16x32_bf16 v[84:87], v[36:39], v[68:71], v[84:87]
    ds_bpermute_b32 v88, v5, v88
    ds_bpermute_b32 v89, v5, v89
    s_waitcnt lgkmcnt(4)
    v_mfma_f32_16x16x32_bf16 v[72:75], v[8:11], v[40:43], 0
    s_nop 0
    v_mfma_f32_16x16x32_bf16 v[76:79], v[24:27], v[40:43], 0
    s_nop 0
    v_mfma_f32_16x16x32_bf16 v[72:75], v[12:15], v[44:47], v[72:75]
    s_nop 0
    v_mfma_f32_16x16x32_bf16 v[76:79], v[28:31], v[44:47], v[76:79]
    s_nop 0
    s_waitcnt lgkmcnt(0)
    buffer_store_dwordx4 v[88:91], v4, s[24:27], s54 offen sc1
    s_add_u32 s54, s54, 4096
    v_mul_f32 v80, s75, v80
    v_mul_f32 v81, s75, v81
    v_mul_f32 v82, s75, v82
    v_mul_f32 v83, s75, v83
    v_add_f32 v84, 0, v84
    v_mfma_f32_16x16x32_bf16 v[72:75], v[16:19], v[48:51], v[72:75]
    v_add_f32 v85, 0, v85
    v_add_f32 v87, 0, v87
    v_add_u32 v86, 0x8000, v86
    v_add_u32 v84, 0x8000, v84
    v_add_u32 v87, 0x8000, v87
    v_mfma_f32_16x16x32_bf16 v[76:79], v[32:35], v[48:51], v[76:79]
    v_add_u32 v85, 0x8000, v85
    v_sub_u32_sdwa v84, v84, v86 clamp dst_sel:DWORD dst_unused:UNUSED_PAD src0_sel:DWORD src1_sel:WORD_1
    v_cvt_pk_bf16_f32 v94, v80, v81
    v_sub_u32_sdwa v87, v87, v84 clamp dst_sel:DWORD dst_unused:UNUSED_PAD src0_sel:DWORD src1_sel:WORD_1
    v_cvt_pk_bf16_f32 v95, v82, v83
    v_mfma_f32_16x16x32_bf16 v[72:75], v[20:23], v[52:55], v[72:75]
    v_sub_u32_sdwa v85, v85, v87 clamp dst_sel:DWORD dst_unused:UNUSED_PAD src0_sel:DWORD src1_sel:WORD_1
    v_perm_b32 v92, v84, v86, s55
    v_perm_b32 v93, v85, v87, s55
    ds_bpermute_b32 v94, v5, v94
    ds_bpermute_b32 v95, v5, v95
    v_mfma_f32_16x16x32_bf16 v[76:79], v[36:39], v[52:55], v[76:79]
    ds_bpermute_b32 v92, v5, v92
    ds_bpermute_b32 v93, v5, v93
    s_nop 3
    v_mul_f32 v72, s75, v72
    v_mul_f32 v73, s75, v73
    v_mul_f32 v74, s75, v74
    v_mul_f32 v75, s75, v75
    v_add_f32 v76, 0, v76
    v_add_f32 v77, 0, v77
    v_add_f32 v79, 0, v79
    v_add_u32 v78, 0x8000, v78
    v_add_u32 v76, 0x8000, v76
    v_add_u32 v79, 0x8000, v79
    v_add_u32 v77, 0x8000, v77
    v_sub_u32_sdwa v76, v76, v78 clamp dst_sel:DWORD dst_unused:UNUSED_PAD src0_sel:DWORD src1_sel:WORD_1
    v_cvt_pk_bf16_f32 v90, v72, v73
    v_sub_u32_sdwa v79, v79, v76 clamp dst_sel:DWORD dst_unused:UNUSED_PAD src0_sel:DWORD src1_sel:WORD_1
    v_cvt_pk_bf16_f32 v91, v74, v75
    v_sub_u32_sdwa v77, v77, v79 clamp dst_sel:DWORD dst_unused:UNUSED_PAD src0_sel:DWORD src1_sel:WORD_1
    v_perm_b32 v88, v76, v78, s55
    v_perm_b32 v89, v77, v79, s55
    s_waitcnt lgkmcnt(0)
    buffer_store_dwordx4 v[92:95], v4, s[24:27], s54 offen sc1
    s_add_u32 s54, s54, 4096
    ds_bpermute_b32 v90, v5, v90
    ds_bpermute_b32 v91, v5, v91
    ds_bpermute_b32 v88, v5, v88
    ds_bpermute_b32 v89, v5, v89
    s_waitcnt lgkmcnt(0)
    s_mov_b32 exec_hi, s56
    buffer_store_dwordx4 v[88:91], v4, s[24:27], s54 offen sc1
    s_add_u32 s54, s54, 4096
    s_setreg_imm32_b32 hwreg(HW_REG_MODE, 4, 2), 3
    s_setprio 0
    s_waitcnt vmcnt(0)
    s_branch L_GD
L_GC:
    s_mov_b32 s54, 0xffff0000
    s_waitcnt vmcnt(0)
    v_and_b32 v10, s54, v10
    v_and_b32 v11, s54, v11
    v_and_b32 v12, s54, v12
    v_and_b32 v13, s54, v13
    v_mul_f32 v10, s75, v10
    v_mul_f32 v11, s75, v11
    v_mul_f32 v12, s75, v12
    v_mul_f32 v13, s75, v13
    v_cvt_pk_bf16_f32 v10, v10, v11
    v_cvt_pk_bf16_f32 v11, v12, v13
    ds_write_b64 v105, v[10:11]
    s_mov_b64 exec, 1
L_LAND2:
    s_sub_u32 s74, s74, 1
    s_cbranch_scc1 L_END
    ds_read_b32 v7, v124 offset:16
    s_waitcnt lgkmcnt(0)
    v_cmp_ne_u32 vcc, 1030, v7
    s_cbranch_vccnz L_LAND2
    s_mov_b64 exec, -1
    ds_read_b128 v[40:43], v96 offset:0
    ds_read_b64_tr_b16 v[8:9], v100 offset:0
    ds_read_b64_tr_b16 v[10:11], v100 offset:512
    ds_read_b64_tr_b16 v[24:25], v100 offset:16384
    ds_read_b64_tr_b16 v[26:27], v100 offset:16896
    ds_read_b128 v[44:47], v97 offset:0
    ds_read_b64_tr_b16 v[12:13], v100 offset:4096
    ds_read_b64_tr_b16 v[14:15], v100 offset:4608
    ds_read_b64_tr_b16 v[28:29], v100 offset:20480
    ds_read_b64_tr_b16 v[30:31], v100 offset:20992
    s_mov_b32 s54, 272
    s_mov_b32 s55, 528
    s_mov_b32 s56, 0
    v_lshlrev_b32 v4, 4, v101
    v_lshl_add_u32 v5, v101, 3, s56
    v_mad_u32_u24 v4, v102, s54, v4
    v_mad_u32_u24 v5, v102, s55, v5
    s_waitcnt lgkmcnt(4)
    ds_read_b128 v[48:51], v98 offset:0
    ds_read_b64_tr_b16 v[16:17], v100 offset:8192
    ds_read_b64_tr_b16 v[18:19], v100 offset:8704
    ds_read_b64_tr_b16 v[32:33], v100 offset:24576
    ds_read_b64_tr_b16 v[34:35], v100 offset:25088
    ds_read_b128 v[52:55], v99 offset:0
    ds_read_b64_tr_b16 v[20:21], v100 offset:12288
    ds_read_b64_tr_b16 v[22:23], v100 offset:12800
    ds_read_b64_tr_b16 v[36:37], v100 offset:28672
    ds_read_b64_tr_b16 v[38:39], v100 offset:29184
    s_waitcnt lgkmcnt(0)
    v_mfma_f32_16x16x32_bf16 v[72:75], v[8:11], v[40:43], 0
    ds_read_b128 v[56:59], v96 offset:4096
    v_mfma_f32_16x16x32_bf16 v[76:79], v[24:27], v[40:43], 0
    ds_read_b128 v[60:63], v97 offset:4096
    v_mfma_f32_16x16x32_bf16 v[72:75], v[12:15], v[44:47], v[72:75]
    ds_read_b128 v[64:67], v98 offset:4096
    v_mfma_f32_16x16x32_bf16 v[76:79], v[28:31], v[44:47], v[76:79]
    ds_read_b128 v[68:71], v99 offset:4096
    v_mfma_f32_16x16x32_bf16 v[72:75], v[16:19], v[48:51], v[72:75]
    v_mfma_f32_16x16x32_bf16 v[76:79], v[32:35], v[48:51], v[76:79]
    v_mfma_f32_16x16x32_bf16 v[72:75], v[20:23], v[52:55], v[72:75]
    v_mfma_f32_16x16x32_bf16 v[76:79], v[36:39], v[52:55], v[76:79]
    s_add_u32 s32, s22, 10485760
    s_addc_u32 s33, s23, 0
    s_mov_b32 s34, 262144
    s_mov_b32 s35, 0x20000
    s_waitcnt lgkmcnt(0)
    s_barrier
    buffer_load_dwordx2 v[88:89], v103, s[32:35], 0 offen sc1
    ds_read_b32 v90, v124 offset:20
    s_waitcnt lgkmcnt(0)
    v_mfma_f32_16x16x32_bf16 v[80:83], v[8:11], v[56:59], 0
    ds_read_b128 v[40:43], v96 offset:8192
    v_mfma_f32_16x16x32_bf16 v[84:87], v[24:27], v[56:59], 0
    ds_read_b128 v[44:47], v97 offset:8192
    v_mfma_f32_16x16x32_bf16 v[80:83], v[12:15], v[60:63], v[80:83]
    ds_read_b128 v[48:51], v98 offset:8192
    v_mfma_f32_16x16x32_bf16 v[84:87], v[28:31], v[60:63], v[84:87]
    ds_read_b128 v[52:55], v99 offset:8192
    v_mul_f32 v72, s75, v72
    v_mfma_f32_16x16x32_bf16 v[80:83], v[16:19], v[64:67], v[80:83]
    v_mul_f32 v73, s75, v73
    v_mfma_f32_16x16x32_bf16 v[84:87], v[32:35], v[64:67], v[84:87]
    v_mul_f32 v74, s75, v74
    v_mfma_f32_16x16x32_bf16 v[80:83], v[20:23], v[68:71], v[80:83]
    v_mul_f32 v75, s75, v75
    v_mfma_f32_16x16x32_bf16 v[84:87], v[36:39], v[68:71], v[84:87]
    ds_write_b128 v4, v[72:75] offset:0
    v_cvt_f64_f32 v[92:93], v76
    v_cvt_f64_f32 v[94:95], v77
    v_cvt_f64_f32 v[104:105], v78
    v_cvt_f64_f32 v[6:7], v79
    ds_write_b64 v5, v[92:93] offset:21760
    ds_write_b64 v5, v[94:95] offset:21888
    ds_write_b64 v5, v[104:105] offset:22016
    ds_write_b64 v5, v[6:7] offset:22144
    s_barrier
    s_waitcnt lgkmcnt(5)
    v_mfma_f32_16x16x32_bf16 v[72:75], v[8:11], v[40:43], 0
    ds_read_b128 v[56:59], v96 offset:12288
    v_mfma_f32_16x16x32_bf16 v[76:79], v[24:27], v[40:43], 0
    ds_read_b128 v[60:63], v97 offset:12288
    v_mfma_f32_16x16x32_bf16 v[72:75], v[12:15], v[44:47], v[72:75]
    ds_read_b128 v[64:67], v98 offset:12288
    v_mfma_f32_16x16x32_bf16 v[76:79], v[28:31], v[44:47], v[76:79]
    ds_read_b128 v[68:71], v99 offset:12288
    v_mul_f32 v80, s75, v80
    v_mfma_f32_16x16x32_bf16 v[72:75], v[16:19], v[48:51], v[72:75]
    v_mul_f32 v81, s75, v81
    v_mfma_f32_16x16x32_bf16 v[76:79], v[32:35], v[48:51], v[76:79]
    v_mul_f32 v82, s75, v82
    v_mfma_f32_16x16x32_bf16 v[72:75], v[20:23], v[52:55], v[72:75]
    v_mul_f32 v83, s75, v83
    v_mfma_f32_16x16x32_bf16 v[76:79], v[36:39], v[52:55], v[76:79]
    ds_write_b128 v4, v[80:83] offset:4352
    v_cvt_f64_f32 v[92:93], v84
    v_cvt_f64_f32 v[94:95], v85
    v_cvt_f64_f32 v[104:105], v86
    v_cvt_f64_f32 v[6:7], v87
    ds_write_b64 v5, v[92:93] offset:30208
    ds_write_b64 v5, v[94:95] offset:30336
    ds_write_b64 v5, v[104:105] offset:30464
    ds_write_b64 v5, v[6:7] offset:30592
    s_waitcnt lgkmcnt(5)
    v_mfma_f32_16x16x32_bf16 v[80:83], v[8:11], v[56:59], 0
    ds_read_b128 v[40:43], v96 offset:16384
    v_mfma_f32_16x16x32_bf16 v[84:87], v[24:27], v[56:59], 0
    ds_read_b128 v[44:47], v97 offset:16384
    v_mfma_f32_16x16x32_bf16 v[80:83], v[12:15], v[60:63], v[80:83]
    ds_read_b128 v[48:51], v98 offset:16384
    v_mfma_f32_16x16x32_bf16 v[84:87], v[28:31], v[60:63], v[84:87]
    ds_read_b128 v[52:55], v99 offset:16384
    v_mul_f32 v72, s75, v72
    v_mfma_f32_16x16x32_bf16 v[80:83], v[16:19], v[64:67], v[80:83]
    v_mul_f32 v73, s75, v73
    v_mfma_f32_16x16x32_bf16 v[84:87], v[32:35], v[64:67], v[84:87]
    v_mul_f32 v74, s75, v74
    v_mfma_f32_16x16x32_bf16 v[80:83], v[20:23], v[68:71], v[80:83]
    v_mul_f32 v75, s75, v75
    v_mfma_f32_16x16x32_bf16 v[84:87], v[36:39], v[68:71], v[84:87]
    ds_write_b128 v4, v[72:75] offset:8704
    v_cvt_f64_f32 v[92:93], v76
    v_cvt_f64_f32 v[94:95], v77
    v_cvt_f64_f32 v[104:105], v78
    v_cvt_f64_f32 v[6:7], v79
    ds_write_b64 v5, v[92:93] offset:38656
    ds_write_b64 v5, v[94:95] offset:38784
    ds_write_b64 v5, v[104:105] offset:38912
    ds_write_b64 v5, v[6:7] offset:39040
    s_waitcnt lgkmcnt(5)
    v_mfma_f32_16x16x32_bf16 v[72:75], v[8:11], v[40:43], 0
    s_nop 0
    v_mfma_f32_16x16x32_bf16 v[76:79], v[24:27], v[40:43], 0
    s_nop 0
    v_mfma_f32_16x16x32_bf16 v[72:75], v[12:15], v[44:47], v[72:75]
    s_nop 0
    v_mfma_f32_16x16x32_bf16 v[76:79], v[28:31], v[44:47], v[76:79]
    s_nop 0
    v_mul_f32 v80, s75, v80
    v_mfma_f32_16x16x32_bf16 v[72:75], v[16:19], v[48:51], v[72:75]
    v_mul_f32 v81, s75, v81
    v_mfma_f32_16x16x32_bf16 v[76:79], v[32:35], v[48:51], v[76:79]
    v_mul_f32 v82, s75, v82
    v_mfma_f32_16x16x32_bf16 v[72:75], v[20:23], v[52:55], v[72:75]
    v_mul_f32 v83, s75, v83
    v_mfma_f32_16x16x32_bf16 v[76:79], v[36:39], v[52:55], v[76:79]
    ds_write_b128 v4, v[80:83] offset:13056
    v_cvt_f64_f32 v[92:93], v84
    v_cvt_f64_f32 v[94:95], v85
    v_cvt_f64_f32 v[104:105], v86
    v_cvt_f64_f32 v[6:7], v87
    ds_write_b64 v5, v[92:93] offset:47104
    ds_write_b64 v5, v[94:95] offset:47232
    ds_write_b64 v5, v[104:105] offset:47360
    ds_write_b64 v5, v[6:7] offset:47488
    s_nop 7
    v_mul_f32 v72, s75, v72
    v_mul_f32 v73, s75, v73
    v_mul_f32 v74, s75, v74
    v_mul_f32 v75, s75, v75
    ds_write_b128 v4, v[72:75] offset:17408
    v_cvt_f64_f32 v[92:93], v76
    v_cvt_f64_f32 v[94:95], v77
    v_cvt_f64_f32 v[104:105], v78
    v_cvt_f64_f32 v[6:7], v79
    ds_write_b64 v5, v[92:93] offset:55552
    ds_write_b64 v5, v[94:95] offset:55680
    ds_write_b64 v5, v[104:105] offset:55808
    ds_write_b64 v5, v[6:7] offset:55936
    s_branch L_PW
L_GD:
    s_mov_b64 exec, -1
    s_add_u32 s32, s22, 10485760
    s_addc_u32 s33, s23, 0
    s_mov_b32 s34, 262144
    s_mov_b32 s35, 0x20000
    s_waitcnt lgkmcnt(0)
    s_barrier
L_TSD:
    buffer_load_dwordx2 v[88:89], v103, s[32:35], 0 offen sc1
    ds_read_b32 v90, v124 offset:20
L_FILL:
    v_lshrrev_b32 v4, 4, v0
    v_and_b32 v5, 15, v0
    s_mov_b32 s54, 784
    v_mov_b32 v6, 66304
    v_mad_u32_u24 v4, v4, s54, v6
    v_mad_u32_u24 v4, v5, 48, v4
    v_mov_b32 v56, 4194304
    v_mov_b32 v57, 4194304
    v_mov_b64 v[58:59], v[56:57]
    s_cmp_lt_u32 s59, 8
    ds_write_b128 v4, v[56:59]
    s_cbranch_scc0 L_FT
    ds_write_b128 v4, v[56:59] offset:37632
    s_branch L_FD
L_FT:
    s_mov_b32 s55, 123648
    v_mov_b32 v60, 65056
    v_mov_b32 v61, 0
    v_lshl_add_u32 v5, v0, 4, s55
    v_mov_b64 v[62:63], v[60:61]
    ds_write_b128 v5, v[60:63]
    ds_write_b128 v5, v[60:63] offset:4096
L_FD:
    s_cmp_eq_u32 s53, 0
    s_waitcnt lgkmcnt(0)
    s_barrier
    s_cbranch_scc1 L_AGAIN
L_PW:
    v_readfirstlane_b32 s71, v90
    s_nop 0
    s_xor_b32 s73, s71, 0x2545F491
    s_mul_i32 s72, s73, 0x9E3779B1
    s_mul_i32 s73, s73, 0x85EBCA6B
    s_lshr_b32 s100, s73, 25
    s_waitcnt vmcnt(0)
L_POLL:
    v_lshrrev_b32 v4, 25, v88
    v_cmp_ne_u32 vcc, s72, v89
    v_cmp_ne_u32 s[54:55], s100, v4
    s_or_b64 exec, vcc, s[54:55]
    s_cbranch_execnz L_POLL2
L_POLLED:
    s_mov_b64 exec, -1
    v_bfe_u32 v127, v88, 14, 11
    v_and_b32 v4, 0x3fff, v88
    v_add_u32 v126, v126, v4
L_WINDOW:
    v_and_b32 v4, 15, v1
    v_and_b32 v5, 3, v1
    v_sub_u32 v5, v127, v5
    v_sub_u32_dpp v64, v127, v4 row_newbcast:0 row_mask:0xf bank_mask:0xf
    v_sub_u32_dpp v65, v127, v4 row_newbcast:4 row_mask:0xf bank_mask:0xf
    v_sub_u32_dpp v66, v127, v4 row_newbcast:8 row_mask:0xf bank_mask:0xf
    v_sub_u32_dpp v67, v127, v4 row_newbcast:12 row_mask:0xf bank_mask:0xf
    v_cmp_lt_i32 s[36:37], 0, v64
    v_cmp_lt_i32 s[38:39], 0, v65
    v_cmp_lt_i32 s[40:41], 0, v66
    v_cmp_lt_i32 s[42:43], 0, v67
    v_cmp_lt_i32 s[44:45], 16, v5
    v_cmp_lt_i32 s[46:47], 20, v5
    v_cmp_lt_i32 s[48:49], 24, v5
L_LOADS:
    v_and_b32 v4, 15, v1
    v_and_b32 v5, 3, v1
    v_mul_u32_u24 v4, 12, v4
    v_mad_u32_u24 v5, v5, 12, v126
    s_or_b64 s[76:77], s[46:47], s[48:49]
    s_or_b64 s[78:79], s[76:77], s[44:45]
    v_add_u32_dpp v11, v126, v4 row_newbcast:0 row_mask:0xf bank_mask:0xf
    v_add_u32_dpp v17, v126, v4 row_newbcast:4 row_mask:0xf bank_mask:0xf
    v_add_u32_dpp v23, v126, v4 row_newbcast:8 row_mask:0xf bank_mask:0xf
    v_add_u32_dpp v29, v126, v4 row_newbcast:12 row_mask:0xf bank_mask:0xf
    s_mov_b64 exec, s[36:37]
    buffer_load_dwordx3 v[8:10], v11, s[28:31], 0 offen sc1
    s_mov_b64 exec, s[38:39]
    buffer_load_dwordx3 v[14:16], v17, s[28:31], 0 offen sc1
    s_mov_b64 exec, s[40:41]
    buffer_load_dwordx3 v[20:22], v23, s[28:31], 0 offen sc1
    s_mov_b64 exec, s[42:43]
    buffer_load_dwordx3 v[26:28], v29, s[28:31], 0 offen sc1
    s_cmp_eq_u64 s[78:79], 0
    s_cbranch_scc1 L_RL
    s_mov_b64 exec, s[44:45]
    buffer_load_dwordx3 v[32:34], v5, s[28:31], 0 offen offset:192 sc1
    s_cmp_eq_u64 s[76:77], 0
    s_cbranch_scc1 L_RL
    s_mov_b64 exec, s[46:47]
    buffer_load_dwordx3 v[38:40], v5, s[28:31], 0 offen offset:240 sc1
    s_mov_b64 exec, s[48:49]
    buffer_load_dwordx3 v[44:46], v5, s[28:31], 0 offen offset:288 sc1
L_RL:
    s_mov_b64 exec, -1
    s_mov_b32 s54, 65792
    v_lshl_add_u32 v4, v1, 3, s54
    ds_read_b64 v[12:13], v4
    ds_read_b64 v[18:19], v4
    ds_read_b64 v[24:25], v4
    ds_read_b64 v[30:31], v4
    ds_read_b64 v[36:37], v4
    ds_read_b64 v[42:43], v4
    ds_read_b64 v[48:49], v4
    ds_read_b64 v[54:55], v4
    s_cmp_ge_u32 s59, 8
    s_cselect_b32 s52, 3, 0
    s_xor_b32 s52, s52, s59
    s_lshl_b32 s54, s52, 5
    s_add_u32 s54, s54, 131840
    v_lshrrev_b32 v4, 4, v1
    v_bfe_u32 v5, v1, 2, 2
    v_lshl_add_u32 v94, v4, 3, s54
    v_lshl_add_u32 v95, v5, 3, s54
    s_lshl_b32 s54, s59, 5
    s_add_u32 s54, s54, s68
    s_lshl_b32 s54, s54, 7
    s_add_u32 s54, s54, 10747904
    v_lshl_add_u32 v100, v1, 7, s54
    v_mov_b32 v6, 66304
    s_mov_b32 s54, 1568
    v_mad_u32_u24 v76, v1, s54, v6
    v_lshlrev_b32 v77, 9, v1
    v_add_u32 v78, 784, v76
    v_add_u32 v79, 256, v77
    v_lshlrev_b32 v80, 3, v1
    v_mov_b32 v6, 66160
    s_mov_b32 s54, 196
    s_mov_b32 s55, 0xffffff00
    s_waitcnt vmcnt(0)
    s_mov_b64 exec, s[36:37]
    v_lshlrev_b32_sdwa v4, 2, v10 dst_sel:DWORD dst_unused:UNUSED_PAD src0_sel:DWORD src1_sel:BYTE_0
    v_lshlrev_b32_sdwa v57, 8, v10 dst_sel:DWORD dst_unused:UNUSED_PAD src0_sel:DWORD src1_sel:BYTE_0
    ds_add_rtn_u32 v11, v4, v125 offset:64512
    v_mad_u32_u24 v56, v4, s54, v6
    v_and_b32 v10, s55, v10
    s_mov_b64 exec, s[38:39]
    v_lshlrev_b32_sdwa v4, 2, v16 dst_sel:DWORD dst_unused:UNUSED_PAD src0_sel:DWORD src1_sel:BYTE_0
    v_lshlrev_b32_sdwa v59, 8, v16 dst_sel:DWORD dst_unused:UNUSED_PAD src0_sel:DWORD src1_sel:BYTE_0
    ds_add_rtn_u32 v17, v4, v125 offset:64512
    v_mad_u32_u24 v58, v4, s54, v6
    v_and_b32 v16, s55, v16
    s_mov_b64 exec, s[40:41]
    v_lshlrev_b32_sdwa v4, 2, v22 dst_sel:DWORD dst_unused:UNUSED_PAD src0_sel:DWORD src1_sel:BYTE_0
    v_lshlrev_b32_sdwa v61, 8, v22 dst_sel:DWORD dst_unused:UNUSED_PAD src0_sel:DWORD src1_sel:BYTE_0
    ds_add_rtn_u32 v23, v4, v125 offset:64512
    v_mad_u32_u24 v60, v4, s54, v6
    v_and_b32 v22, s55, v22
    s_mov_b64 exec, s[42:43]
    v_lshlrev_b32_sdwa v4, 2, v28 dst_sel:DWORD dst_unused:UNUSED_PAD src0_sel:DWORD src1_sel:BYTE_0
    v_lshlrev_b32_sdwa v63, 8, v28 dst_sel:DWORD dst_unused:UNUSED_PAD src0_sel:DWORD src1_sel:BYTE_0
    ds_add_rtn_u32 v29, v4, v125 offset:64512
    v_mad_u32_u24 v62, v4, s54, v6
    v_and_b32 v28, s55, v28
    s_cmp_eq_u64 s[78:79], 0
    s_cbranch_scc1 L_HD
    s_mov_b64 exec, s[44:45]
    v_lshlrev_b32_sdwa v4, 2, v34 dst_sel:DWORD dst_unused:UNUSED_PAD src0_sel:DWORD src1_sel:BYTE_0
    v_lshlrev_b32_sdwa v65, 8, v34 dst_sel:DWORD dst_unused:UNUSED_PAD src0_sel:DWORD src1_sel:BYTE_0
    ds_add_rtn_u32 v35, v4, v125 offset:64512
    v_mad_u32_u24 v64, v4, s54, v6
    v_and_b32 v34, s55, v34
    s_cmp_eq_u64 s[76:77], 0
    s_cbranch_scc1 L_HD
    s_mov_b64 exec, s[46:47]
    v_lshlrev_b32_sdwa v4, 2, v40 dst_sel:DWORD dst_unused:UNUSED_PAD src0_sel:DWORD src1_sel:BYTE_0
    v_lshlrev_b32_sdwa v67, 8, v40 dst_sel:DWORD dst_unused:UNUSED_PAD src0_sel:DWORD src1_sel:BYTE_0
    ds_add_rtn_u32 v41, v4, v125 offset:64512
    v_mad_u32_u24 v66, v4, s54, v6
    v_and_b32 v40, s55, v40
    s_mov_b64 exec, s[48:49]
    v_lshlrev_b32_sdwa v4, 2, v46 dst_sel:DWORD dst_unused:UNUSED_PAD src0_sel:DWORD src1_sel:BYTE_0
    v_lshlrev_b32_sdwa v69, 8, v46 dst_sel:DWORD dst_unused:UNUSED_PAD src0_sel:DWORD src1_sel:BYTE_0
    ds_add_rtn_u32 v47, v4, v125 offset:64512
    v_mad_u32_u24 v68, v4, s54, v6
    v_and_b32 v46, s55, v46
L_HD:
    s_cmp_lt_u32 s59, 4
    s_cbranch_scc0 L_NTF
    s_mov_b32 exec_lo, -1
    s_mov_b32 exec_hi, 0
    global_load_dwordx2 v[70:71], v100, s[22:23] sc1
L_NTF:
    s_mov_b32 s56, 0
    s_waitcnt lgkmcnt(0)
    s_mov_b64 exec, s[36:37]
    v_cmpx_gt_u32 vcc, 64, v11
    v_lshrrev_b32 v4, 2, v11
    v_and_b32 v5, 15, v11
    v_and_b32 v11, 3, v11
    s_andn2_b64 s[36:37], s[36:37], vcc
    v_mad_u32_u24 v56, v4, 48, v56
    v_cmp_eq_u32 vcc, 12, v5
    v_lshl_add_u32 v4, v11, 2, v56
    v_lshl_add_u32 v5, v11, 3, v56
    ds_write_b32 v4, v10 offset:144
    ds_write_b64 v5, v[8:9] offset:160
    s_and_b64 s[80:81], vcc, exec
    s_bcnt1_i32_b64 s57, s[80:81]
    s_add_u32 s56, s56, s57
    s_mov_b64 exec, s[38:39]
    v_cmpx_gt_u32 vcc, 64, v17
    v_lshrrev_b32 v4, 2, v17
    v_and_b32 v5, 15, v17
    v_and_b32 v17, 3, v17
    s_andn2_b64 s[38:39], s[38:39], vcc
    v_mad_u32_u24 v58, v4, 48, v58
    v_cmp_eq_u32 vcc, 12, v5
    v_lshl_add_u32 v4, v17, 2, v58
    v_lshl_add_u32 v5, v17, 3, v58
    ds_write_b32 v4, v16 offset:144
    ds_write_b64 v5, v[14:15] offset:160
    s_and_b64 s[82:83], vcc, exec
    s_bcnt1_i32_b64 s57, s[82:83]
    s_add_u32 s56, s56, s57
    s_mov_b64 exec, s[40:41]
    v_cmpx_gt_u32 vcc, 64, v23
    v_lshrrev_b32 v4, 2, v23
    v_and_b32 v5, 15, v23
    v_and_b32 v23, 3, v23
    s_andn2_b64 s[40:41], s[40:41], vcc
    v_mad_u32_u24 v60, v4, 48, v60
    v_cmp_eq_u32 vcc, 12, v5
    v_lshl_add_u32 v4, v23, 2, v60
    v_lshl_add_u32 v5, v23, 3, v60
    ds_write_b32 v4, v22 offset:144
    ds_write_b64 v5, v[20:21] offset:160
    s_and_b64 s[84:85], vcc, exec
    s_bcnt1_i32_b64 s57, s[84:85]
    s_add_u32 s56, s56, s57
    s_mov_b64 exec, s[42:43]
    v_cmpx_gt_u32 vcc, 64, v29
    v_lshrrev_b32 v4, 2, v29
    v_and_b32 v5, 15, v29
    v_and_b32 v29, 3, v29
    s_andn2_b64 s[42:43], s[42:43], vcc
    v_mad_u32_u24 v62, v4, 48, v62
    v_cmp_eq_u32 vcc, 12, v5
    v_lshl_add_u32 v4, v29, 2, v62
    v_lshl_add_u32 v5, v29, 3, v62
    ds_write_b32 v4, v28 offset:144
    ds_write_b64 v5, v[26:27] offset:160
    s_and_b64 s[86:87], vcc, exec
    s_bcnt1_i32_b64 s57, s[86:87]
    s_add_u32 s56, s56, s57
    s_cmp_eq_u64 s[78:79], 0
    s_cbranch_scc1 L_SD
    s_mov_b64 exec, s[44:45]
    v_cmpx_gt_u32 vcc, 64, v35
    v_lshrrev_b32 v4, 2, v35
    v_and_b32 v5, 15, v35
    v_and_b32 v35, 3, v35
    s_andn2_b64 s[44:45], s[44:45], vcc
    v_mad_u32_u24 v64, v4, 48, v64
    v_cmp_eq_u32 vcc, 12, v5
    v_lshl_add_u32 v4, v35, 2, v64
    v_lshl_add_u32 v5, v35, 3, v64
    ds_write_b32 v4, v34 offset:144
    ds_write_b64 v5, v[32:33] offset:160
    s_and_b64 s[88:89], vcc, exec
    s_bcnt1_i32_b64 s57, s[88:89]
    s_add_u32 s56, s56, s57
    s_cmp_eq_u64 s[76:77], 0
    s_cbranch_scc1 L_SD
    s_mov_b64 exec, s[46:47]
    v_cmpx_gt_u32 vcc, 64, v41
    v_lshrrev_b32 v4, 2, v41
    v_and_b32 v5, 15, v41
    v_and_b32 v41, 3, v41
    s_andn2_b64 s[46:47], s[46:47], vcc
    v_mad_u32_u24 v66, v4, 48, v66
    v_cmp_eq_u32 vcc, 12, v5
    v_lshl_add_u32 v4, v41, 2, v66
    v_lshl_add_u32 v5, v41, 3, v66
    ds_write_b32 v4, v40 offset:144
    ds_write_b64 v5, v[38:39] offset:160
    s_and_b64 s[90:91], vcc, exec
    s_bcnt1_i32_b64 s57, s[90:91]
    s_add_u32 s56, s56, s57
    s_mov_b64 exec, s[48:49]
    v_cmpx_gt_u32 vcc, 64, v47
    v_lshrrev_b32 v4, 2, v47
    v_and_b32 v5, 15, v47
    v_and_b32 v47, 3, v47
    s_andn2_b64 s[48:49], s[48:49], vcc
    v_mad_u32_u24 v68, v4, 48, v68
    v_cmp_eq_u32 vcc, 12, v5
    v_lshl_add_u32 v4, v47, 2, v68
    v_lshl_add_u32 v5, v47, 3, v68
    ds_write_b32 v4, v46 offset:144
    ds_write_b64 v5, v[44:45] offset:160
    s_and_b64 s[92:93], vcc, exec
    s_bcnt1_i32_b64 s57, s[92:93]
    s_add_u32 s56, s56, s57
L_SD:
    s_mov_b64 exec, 1
    v_mov_b32 v4, s56
    ds_add_rtn_u32 v7, v124, v4 offset:4
    s_mov_b64 exec, -1
    v_cmp_lt_i32 vcc, 28, v127
    s_or_b64 s[54:55], s[36:37], s[38:39]
    s_or_b64 s[56:57], s[40:41], s[42:43]
    s_or_b64 s[54:55], s[54:55], s[44:45]
    s_or_b64 s[56:57], s[56:57], s[46:47]
    s_or_b64 s[54:55], s[54:55], s[48:49]
    s_or_b64 s[54:55], s[54:55], s[56:57]
    s_cselect_b32 s51, 1, 0
    s_or_b64 exec, vcc, s[54:55]
    ds_write_b32 v124, v125 offset:0
    s_waitcnt lgkmcnt(1)
    v_readlane_b32 s56, v7, 0
    s_lshl_b32 s56, s56, 3
    s_add_u32 s56, s56, 131840
    s_mov_b64 exec, s[80:81]
    v_mbcnt_lo_u32_b32 v4, exec_lo, 0
    v_mbcnt_hi_u32_b32 v4, exec_hi, v4
    v_lshl_add_u32 v4, v4, 3, s56
    s_bcnt1_i32_b64 s57, exec
    s_lshl3_add_u32 s56, s57, s56
    ds_write_b64 v4, v[56:57]
    s_mov_b64 exec, s[82:83]
    v_mbcnt_lo_u32_b32 v4, exec_lo, 0
    v_mbcnt_hi_u32_b32 v4, exec_hi, v4
    v_lshl_add_u32 v4, v4, 3, s56
    s_bcnt1_i32_b64 s57, exec
    s_lshl3_add_u32 s56, s57, s56
    ds_write_b64 v4, v[58:59]
    s_mov_b64 exec, s[84:85]
    v_mbcnt_lo_u32_b32 v4, exec_lo, 0
    v_mbcnt_hi_u32_b32 v4, exec_hi, v4
    v_lshl_add_u32 v4, v4, 3, s56
    s_bcnt1_i32_b64 s57, exec
    s_lshl3_add_u32 s56, s57, s56
    ds_write_b64 v4, v[60:61]
    s_mov_b64 exec, s[86:87]
    v_mbcnt_lo_u32_b32 v4, exec_lo, 0
    v_mbcnt_hi_u32_b32 v4, exec_hi, v4
    v_lshl_add_u32 v4, v4, 3, s56
    s_bcnt1_i32_b64 s57, exec
    s_lshl3_add_u32 s56, s57, s56
    ds_write_b64 v4, v[62:63]
    s_cmp_eq_u64 s[78:79], 0
    s_cbranch_scc1 L_TD
    s_mov_b64 exec, s[88:89]
    v_mbcnt_lo_u32_b32 v4, exec_lo, 0
    v_mbcnt_hi_u32_b32 v4, exec_hi, v4
    v_lshl_add_u32 v4, v4, 3, s56
    s_bcnt1_i32_b64 s57, exec
    s_lshl3_add_u32 s56, s57, s56
    ds_write_b64 v4, v[64:65]
    s_cmp_eq_u64 s[76:77], 0
    s_cbranch_scc1 L_TD
    s_mov_b64 exec, s[90:91]
    v_mbcnt_lo_u32_b32 v4, exec_lo, 0
    v_mbcnt_hi_u32_b32 v4, exec_hi, v4
    v_lshl_add_u32 v4, v4, 3, s56
    s_bcnt1_i32_b64 s57, exec
    s_lshl3_add_u32 s56, s57, s56
    ds_write_b64 v4, v[66:67]
    s_mov_b64 exec, s[92:93]
    v_mbcnt_lo_u32_b32 v4, exec_lo, 0
    v_mbcnt_hi_u32_b32 v4, exec_hi, v4
    v_lshl_add_u32 v4, v4, 3, s56
    s_bcnt1_i32_b64 s57, exec
    s_lshl3_add_u32 s56, s57, s56
    ds_write_b64 v4, v[68:69]
L_TD:
    s_mov_b64 exec, 1
    ds_add_u32 v124, v125 offset:8
    s_mov_b32 s53, 0
    s_mov_b32 s0, 0
    s_cmp_lt_u32 s59, 8
    s_cbranch_scc1 L_EG
L_EGD:
    s_mov_b64 exec, -1
    s_waitcnt lgkmcnt(0)
    s_lshl4_add_u32 s54, s2, s59
    s_cmp_eq_u32 s54, 15
    s_barrier
    s_cbranch_scc1 L_EPO
L_EPD:
    ds_read_b64 v[4:5], v124 offset:0
    ds_read_b64 v[96:97], v80 offset:64512
L_PRE:
    ds_read_b64 v[88:89], v94
    ds_read_b32 v93, v95
    s_setprio 3
    v_mov_b32 v92, v3
    v_mov_b64 v[100:101], 0
    v_mov_b64 v[102:103], 0
    s_waitcnt lgkmcnt(1)
    ds_read_b128 v[60:63], v88
    ds_read_b128 v[84:87], v88 offset:48
    v_readfirstlane_b32 s54, v5
    v_readfirstlane_b32 s58, v4
    v_pk_fma_f32 v[90:91], v[88:89], s[62:63], v[2:3] op_sel:[1,0,0] op_sel_hi:[1,1,1]
    s_cmp_lt_u32 s54, 64
    s_cbranch_scc1 L_FEW
    s_cmp_eq_u32 s0, 0
    s_waitcnt lgkmcnt(1)
    s_cbranch_scc0 L_G1
    v_pk_add_f32 v[60:61], v[60:61], v[2:3] op_sel_hi:[1,0]
    v_pk_add_f32 v[62:63], v[62:63], v[2:3] op_sel_hi:[1,0]
    buffer_load_dwordx4 v[8:11], v60, s[24:27], 0 offen sc1
    buffer_load_dwordx4 v[14:17], v61, s[24:27], 0 offen sc1
    buffer_load_dwordx4 v[20:23], v62, s[24:27], 0 offen sc1
    buffer_load_dwordx4 v[26:29], v63, s[24:27], 0 offen sc1
L_G1:
    ds_read_b128 v[80:83], v90 offset:0
    s_mov_b64 exec, s[66:67]
    ds_read_b64 v[110:111], v93 offset:16
    ds_read_b64 v[114:115], v93 offset:24
    ds_read_b64 v[118:119], v93 offset:32
    ds_read_b64 v[122:123], v93 offset:40
    s_mov_b64 exec, -1
    v_mov_b32 v72, 1.0
    v_mov_b32 v73, 1.0
    v_mov_b32 v74, 1.0
    v_mov_b32 v75, 1.0
    s_cmp_eq_u32 s54, -1
    s_cbranch_scc1 L_SB3
    v_min_u32 v96, 64, v96
    v_add_u32 v98, 15, v96
    v_lshrrev_b32 v96, 4, v96
    v_bfe_u32 v98, v98, 2, 2
    v_min_u32 v97, 64, v97
    v_add_u32 v99, 15, v97
    v_lshrrev_b32 v97, 4, v97
    v_bfe_u32 v99, v99, 2, 2
    s_mov_b32 s57, 192
    v_mad_u32_u24 v76, v96, s57, v76
    v_mad_u32_u24 v78, v97, s57, v78
    s_lshl3_add_u32 s56, s54, 131840
    v_cmp_eq_u32 s[80:81], 2, v98
    v_cmp_eq_u32 s[82:83], 2, v99
    v_cmp_eq_u32 s[84:85], 1, v98
    v_cmp_eq_u32 s[86:87], 1, v99
    v_cmp_eq_u32 s[88:89], 0, v98
    v_cmp_eq_u32 s[90:91], 0, v99
    s_mov_b32 s76, s56
    s_mov_b64 exec, s[80:81]
    v_mbcnt_lo_u32_b32 v96, exec_lo, 0
    v_mbcnt_hi_u32_b32 v96, exec_hi, v96
    v_lshl_add_u32 v96, v96, 3, s56
    s_bcnt1_i32_b64 s57, exec
    s_lshl3_add_u32 s56, s57, s56
    ds_write_b64 v96, v[76:77]
    s_mov_b64 exec, s[82:83]
    v_mbcnt_lo_u32_b32 v96, exec_lo, 0
    v_mbcnt_hi_u32_b32 v96, exec_hi, v96
    v_lshl_add_u32 v96, v96, 3, s56
    s_bcnt1_i32_b64 s57, exec
    s_lshl3_add_u32 s56, s57, s56
    ds_write_b64 v96, v[78:79]
    s_mov_b32 s77, s56
    s_mov_b64 exec, s[84:85]
    v_mbcnt_lo_u32_b32 v96, exec_lo, 0
    v_mbcnt_hi_u32_b32 v96, exec_hi, v96
    v_lshl_add_u32 v96, v96, 3, s56
    s_bcnt1_i32_b64 s57, exec
    s_lshl3_add_u32 s56, s57, s56
    ds_write_b64 v96, v[76:77]
    s_mov_b64 exec, s[86:87]
    v_mbcnt_lo_u32_b32 v96, exec_lo, 0
    v_mbcnt_hi_u32_b32 v96, exec_hi, v96
    v_lshl_add_u32 v96, v96, 3, s56
    s_bcnt1_i32_b64 s57, exec
    s_lshl3_add_u32 s56, s57, s56
    ds_write_b64 v96, v[78:79]
    s_mov_b32 s78, s56
    s_mov_b64 exec, s[88:89]
    v_mbcnt_lo_u32_b32 v96, exec_lo, 0
    v_mbcnt_hi_u32_b32 v96, exec_hi, v96
    v_lshl_add_u32 v96, v96, 3, s56
    s_bcnt1_i32_b64 s57, exec
    s_lshl3_add_u32 s56, s57, s56
    ds_write_b64 v96, v[76:77]
    s_mov_b64 exec, s[90:91]
    v_mbcnt_lo_u32_b32 v96, exec_lo, 0
    v_mbcnt_hi_u32_b32 v96, exec_hi, v96
    v_lshl_add_u32 v96, v96, 3, s56
    s_bcnt1_i32_b64 s57, exec
    s_lshl3_add_u32 s56, s57, s56
    ds_write_b64 v96, v[78:79]
    s_mov_b64 exec, -1
    s_sub_u32 s56, s56, 131816
    s_lshr_b32 s56, s56, 5
    s_sub_u32 s56, s56, s52
    s_add_u32 s56, s56, 15
    s_lshr_b32 s56, s56, 4
    s_lshl4_add_u32 s57, s56, s52
    s_lshl_b32 s57, s57, 5
    s_add_u32 s57, s57, 131328
    s_lshl2_add_u32 s50, s56, -2
    s_cmp_lt_u32 s57, s76
    s_addc_u32 s50, s50, 0
    s_cmp_lt_u32 s57, s77
    s_addc_u32 s50, s50, 0
    s_cmp_lt_u32 s57, s78
    s_addc_u32 s50, s50, 0
    s_branch L_SB3
L_L0:
    s_cmp_eq_u32 s50, 1
    v_exp_f32 v56, v56
    v_exp_f32 v57, v57
    v_exp_f32 v58, v58
    v_exp_f32 v59, v59
    v_exp_f32 v60, v60
    v_exp_f32 v61, v61
    v_exp_f32 v62, v62
    v_exp_f32 v63, v63
    s_mov_b64 exec, s[66:67]
    ds_read_b64 v[110:111], v93 offset:64
    ds_read_b64 v[114:115], v93 offset:72
    ds_read_b64 v[118:119], v93 offset:80
    ds_read_b64 v[122:123], v93 offset:88
    s_mov_b64 exec, -1
    v_exp_f32 v64, v64
    v_exp_f32 v65, v65
    v_exp_f32 v66, v66
    v_exp_f32 v67, v67
    v_exp_f32 v68, v68
    v_exp_f32 v69, v69
    v_exp_f32 v70, v70
    v_exp_f32 v71, v71
    s_cbranch_scc1 L_NL0_16
    buffer_load_dwordx4 v[32:35], v84, s[24:27], 0 offen sc1
    buffer_load_dwordx4 v[38:41], v85, s[24:27], 0 offen sc1
    buffer_load_dwordx4 v[44:47], v86, s[24:27], 0 offen sc1
    buffer_load_dwordx4 v[50:53], v87, s[24:27], 0 offen sc1
L_NL0_16:
    ds_read_b128 v[84:87], v88 offset:96
    v_pk_mul_f32 v[100:101], v[100:101], v[72:73]
    v_pk_mul_f32 v[102:103], v[102:103], v[74:75]
    v_cvt_f64_f32 v[76:77], v100
    v_cvt_f64_f32 v[78:79], v101
    v_cvt_f64_f32 v[4:5], v102
    v_cvt_f64_f32 v[6:7], v103
    ds_add_f64 v92, v[76:77] offset:0
    ds_add_f64 v92, v[78:79] offset:128
    ds_add_f64 v92, v[4:5] offset:256
    ds_add_f64 v92, v[6:7] offset:384
    v_pk_add_f32 v[72:73], v[56:57], 1.0 op_sel_hi:[1,0]
    v_pk_add_f32 v[74:75], v[58:59], 1.0 op_sel_hi:[1,0]
    v_pk_fma_f32 v[4:5], v[8:9], v[60:61], v[8:9]
    v_pk_fma_f32 v[6:7], v[96:97], v[62:63], v[96:97]
    v_pk_fma_f32 v[100:101], v[14:15], v[72:73], v[4:5]
    v_pk_fma_f32 v[102:103], v[98:99], v[74:75], v[6:7]
    v_pk_fma_f32 v[72:73], v[72:73], v[60:61], v[72:73]
    v_pk_fma_f32 v[74:75], v[74:75], v[62:63], v[74:75]
    v_pk_fma_f32 v[4:5], v[100:101], v[64:65], v[100:101]
    v_pk_fma_f32 v[6:7], v[102:103], v[66:67], v[102:103]
    v_pk_fma_f32 v[100:101], v[20:21], v[72:73], v[4:5]
    v_pk_fma_f32 v[102:103], v[104:105], v[74:75], v[6:7]
    v_pk_fma_f32 v[72:73], v[72:73], v[64:65], v[72:73]
    v_pk_fma_f32 v[74:75], v[74:75], v[66:67], v[74:75]
    v_pk_fma_f32 v[4:5], v[100:101], v[68:69], v[100:101]
    v_pk_fma_f32 v[6:7], v[102:103], v[70:71], v[102:103]
    v_pk_fma_f32 v[100:101], v[26:27], v[72:73], v[4:5]
    v_pk_fma_f32 v[102:103], v[124:125], v[74:75], v[6:7]
    v_pk_fma_f32 v[72:73], v[72:73], v[68:69], v[72:73]
    v_pk_fma_f32 v[74:75], v[74:75], v[70:71], v[74:75]
L_SB0:
    s_cmp_eq_u32 s50, 1
    s_waitcnt lgkmcnt(0)
    v_pk_add_f32 v[84:85], v[84:85], v[2:3] op_sel_hi:[1,0]
    v_pk_add_f32 v[86:87], v[86:87], v[2:3] op_sel_hi:[1,0]
    s_cbranch_scc1 L_CUT
L_M0:
    s_waitcnt vmcnt(2)
    v_mfma_f32_16x16x32_bf16 v[56:59], v[108:111], v[34:37], v[80:83]
    v_lshlrev_b64 v[96:97], 16, v[32:33]
    v_mfma_f32_16x16x32_bf16 v[60:63], v[112:115], v[40:43], v[80:83]
    v_lshlrev_b64 v[98:99], 16, v[38:39]
    s_waitcnt vmcnt(0)
    v_mfma_f32_16x16x32_bf16 v[64:67], v[116:119], v[46:49], v[80:83]
    v_lshlrev_b64 v[104:105], 16, v[44:45]
    v_mfma_f32_16x16x32_bf16 v[68:71], v[120:123], v[52:55], v[80:83]
    v_lshlrev_b64 v[124:125], 16, v[50:51]
    s_sub_u32 s50, s50, 1
    s_bitcmp1_b32 38, s50
    s_cbranch_scc1 L_PR0
L_L1:
    s_cmp_eq_u32 s50, 1
    v_exp_f32 v56, v56
    v_exp_f32 v57, v57
    v_exp_f32 v58, v58
    v_exp_f32 v59, v59
    v_exp_f32 v60, v60
    v_exp_f32 v61, v61
    v_exp_f32 v62, v62
    v_exp_f32 v63, v63
    s_mov_b64 exec, s[66:67]
    ds_read_b64 v[110:111], v93 offset:112
    ds_read_b64 v[114:115], v93 offset:120
    ds_read_b64 v[118:119], v93 offset:128
    ds_read_b64 v[122:123], v93 offset:136
    s_mov_b64 exec, -1
    v_exp_f32 v64, v64
    v_exp_f32 v65, v65
    v_exp_f32 v66, v66
    v_exp_f32 v67, v67
    v_exp_f32 v68, v68
    v_exp_f32 v69, v69
    v_exp_f32 v70, v70
    v_exp_f32 v71, v71
    s_cbranch_scc1 L_NL1_16
    buffer_load_dwordx4 v[8:11], v84, s[24:27], 0 offen sc1
    buffer_load_dwordx4 v[14:17], v85, s[24:27], 0 offen sc1
    buffer_load_dwordx4 v[20:23], v86, s[24:27], 0 offen sc1
    buffer_load_dwordx4 v[26:29], v87, s[24:27], 0 offen sc1
L_NL1_16:
    ds_read_b128 v[84:87], v88 offset:144
    ds_read_b64 v[88:89], v94 offset:512
    v_pk_fma_f32 v[4:5], v[100:101], v[56:57], v[100:101]
    v_pk_fma_f32 v[6:7], v[102:103], v[58:59], v[102:103]
    v_pk_fma_f32 v[100:101], v[32:33], v[72:73], v[4:5]
    v_pk_fma_f32 v[102:103], v[96:97], v[74:75], v[6:7]
    v_pk_fma_f32 v[72:73], v[72:73], v[56:57], v[72:73]
    v_pk_fma_f32 v[74:75], v[74:75], v[58:59], v[74:75]
    v_pk_fma_f32 v[4:5], v[100:101], v[60:61], v[100:101]
    v_pk_fma_f32 v[6:7], v[102:103], v[62:63], v[102:103]
    v_pk_fma_f32 v[100:101], v[38:39], v[72:73], v[4:5]
    v_pk_fma_f32 v[102:103], v[98:99], v[74:75], v[6:7]
    v_pk_fma_f32 v[72:73], v[72:73], v[60:61], v[72:73]
    v_pk_fma_f32 v[74:75], v[74:75], v[62:63], v[74:75]
    v_pk_fma_f32 v[4:5], v[100:101], v[64:65], v[100:101]
    v_pk_fma_f32 v[6:7], v[102:103], v[66:67], v[102:103]
    v_pk_fma_f32 v[100:101], v[44:45], v[72:73], v[4:5]
    v_pk_fma_f32 v[102:103], v[104:105], v[74:75], v[6:7]
    v_pk_fma_f32 v[72:73], v[72:73], v[64:65], v[72:73]
    v_pk_fma_f32 v[74:75], v[74:75], v[66:67], v[74:75]
    v_pk_fma_f32 v[4:5], v[100:101], v[68:69], v[100:101]
    v_pk_fma_f32 v[6:7], v[102:103], v[70:71], v[102:103]
    v_pk_fma_f32 v[100:101], v[50:51], v[72:73], v[4:5]
    v_pk_fma_f32 v[102:103], v[124:125], v[74:75], v[6:7]
    v_pk_fma_f32 v[72:73], v[72:73], v[68:69], v[72:73]
    v_pk_fma_f32 v[74:75], v[74:75], v[70:71], v[74:75]
L_SB1:
    s_cmp_eq_u32 s50, 1
    s_waitcnt lgkmcnt(0)
    v_pk_add_f32 v[84:85], v[84:85], v[2:3] op_sel_hi:[1,0]
    v_pk_add_f32 v[86:87], v[86:87], v[2:3] op_sel_hi:[1,0]
    s_cbranch_scc1 L_CUT
L_M1:
    s_waitcnt vmcnt(2)
    v_mfma_f32_16x16x32_bf16 v[56:59], v[108:111], v[10:13], v[80:83]
    v_lshlrev_b64 v[96:97], 16, v[8:9]
    v_mfma_f32_16x16x32_bf16 v[60:63], v[112:115], v[16:19], v[80:83]
    v_lshlrev_b64 v[98:99], 16, v[14:15]
    s_waitcnt vmcnt(0)
    v_mfma_f32_16x16x32_bf16 v[64:67], v[116:119], v[22:25], v[80:83]
    v_lshlrev_b64 v[104:105], 16, v[20:21]
    v_mfma_f32_16x16x32_bf16 v[68:71], v[120:123], v[28:31], v[80:83]
    v_lshlrev_b64 v[124:125], 16, v[26:27]
    s_sub_u32 s50, s50, 1
    s_bitcmp1_b32 38, s50
    s_cbranch_scc1 L_PR1
L_L2:
    s_cmp_eq_u32 s50, 1
    v_exp_f32 v56, v56
    v_exp_f32 v57, v57
    v_exp_f32 v58, v58
    v_exp_f32 v59, v59
    v_exp_f32 v60, v60
    v_exp_f32 v61, v61
    v_exp_f32 v62, v62
    v_exp_f32 v63, v63
    s_mov_b64 exec, s[66:67]
    ds_read_b64 v[110:111], v93 offset:160
    ds_read_b64 v[114:115], v93 offset:168
    ds_read_b64 v[118:119], v93 offset:176
    ds_read_b64 v[122:123], v93 offset:184
    s_mov_b64 exec, -1
    ds_read_b32 v93, v95 offset:512
    v_exp_f32 v64, v64
    v_exp_f32 v65, v65
    v_exp_f32 v66, v66
    v_exp_f32 v67, v67
    v_exp_f32 v68, v68
    v_exp_f32 v69, v69
    v_exp_f32 v70, v70
    v_exp_f32 v71, v71
    s_cbranch_scc1 L_NL2_16
    buffer_load_dwordx4 v[32:35], v84, s[24:27], 0 offen sc1
    buffer_load_dwordx4 v[38:41], v85, s[24:27], 0 offen sc1
    buffer_load_dwordx4 v[44:47], v86, s[24:27], 0 offen sc1
    buffer_load_dwordx4 v[50:53], v87, s[24:27], 0 offen sc1
L_NL2_16:
    ds_read_b128 v[84:87], v88 offset:0
    v_pk_fma_f32 v[4:5], v[100:101], v[56:57], v[100:101]
    v_pk_fma_f32 v[6:7], v[102:103], v[58:59], v[102:103]
    v_pk_fma_f32 v[100:101], v[8:9], v[72:73], v[4:5]
    v_pk_fma_f32 v[102:103], v[96:97], v[74:75], v[6:7]
    v_pk_fma_f32 v[72:73], v[72:73], v[56:57], v[72:73]
    v_pk_fma_f32 v[74:75], v[74:75], v[58:59], v[74:75]
    v_pk_fma_f32 v[4:5], v[100:101], v[60:61], v[100:101]
    v_pk_fma_f32 v[6:7], v[102:103], v[62:63], v[102:103]
    v_pk_fma_f32 v[100:101], v[14:15], v[72:73], v[4:5]
    v_pk_fma_f32 v[102:103], v[98:99], v[74:75], v[6:7]
    v_pk_fma_f32 v[72:73], v[72:73], v[60:61], v[72:73]
    v_pk_fma_f32 v[74:75], v[74:75], v[62:63], v[74:75]
    v_pk_fma_f32 v[4:5], v[100:101], v[64:65], v[100:101]
    v_pk_fma_f32 v[6:7], v[102:103], v[66:67], v[102:103]
    v_pk_fma_f32 v[100:101], v[20:21], v[72:73], v[4:5]
    v_pk_fma_f32 v[102:103], v[104:105], v[74:75], v[6:7]
    v_pk_fma_f32 v[72:73], v[72:73], v[64:65], v[72:73]
    v_pk_fma_f32 v[74:75], v[74:75], v[66:67], v[74:75]
    v_pk_fma_f32 v[4:5], v[100:101], v[68:69], v[100:101]
    v_pk_fma_f32 v[6:7], v[102:103], v[70:71], v[102:103]
    v_pk_fma_f32 v[100:101], v[26:27], v[72:73], v[4:5]
    v_pk_fma_f32 v[102:103], v[124:125], v[74:75], v[6:7]
    v_pk_fma_f32 v[72:73], v[72:73], v[68:69], v[72:73]
    v_pk_fma_f32 v[74:75], v[74:75], v[70:71], v[74:75]
L_SB2:
    s_cmp_eq_u32 s50, 1
    s_waitcnt lgkmcnt(0)
    v_pk_add_f32 v[84:85], v[84:85], v[2:3] op_sel_hi:[1,0]
    v_pk_add_f32 v[86:87], v[86:87], v[2:3] op_sel_hi:[1,0]
    s_cbranch_scc1 L_CUT
L_M2:
    s_waitcnt vmcnt(2)
    v_mfma_f32_16x16x32_bf16 v[56:59], v[108:111], v[34:37], v[80:83]
    v_lshlrev_b64 v[96:97], 16, v[32:33]
    v_mfma_f32_16x16x32_bf16 v[60:63], v[112:115], v[40:43], v[80:83]
    v_lshlrev_b64 v[98:99], 16, v[38:39]
    s_waitcnt vmcnt(0)
    v_mfma_f32_16x16x32_bf16 v[64:67], v[116:119], v[46:49], v[80:83]
    v_lshlrev_b64 v[104:105], 16, v[44:45]
    v_mfma_f32_16x16x32_bf16 v[68:71], v[120:123], v[52:55], v[80:83]
    v_lshlrev_b64 v[124:125], 16, v[50:51]
    s_sub_u32 s50, s50, 1
    s_bitcmp1_b32 38, s50
    s_cbranch_scc1 L_PR2
L_L3:
    s_cmp_eq_u32 s50, 1
    v_exp_f32 v56, v56
    v_exp_f32 v57, v57
    v_exp_f32 v58, v58
    v_exp_f32 v59, v59
    v_exp_f32 v60, v60
    v_exp_f32 v61, v61
    v_exp_f32 v62, v62
    v_exp_f32 v63, v63
    s_mov_b64 exec, s[66:67]
    ds_read_b64 v[110:111], v93 offset:16
    ds_read_b64 v[114:115], v93 offset:24
    ds_read_b64 v[118:119], v93 offset:32
    ds_read_b64 v[122:123], v93 offset:40
    s_mov_b64 exec, -1
    v_mov_b32 v92, v91
    v_exp_f32 v64, v64
    v_exp_f32 v65, v65
    v_exp_f32 v66, v66
    v_exp_f32 v67, v67
    v_exp_f32 v68, v68
    v_exp_f32 v69, v69
    v_exp_f32 v70, v70
    v_exp_f32 v71, v71
    s_cbranch_scc1 L_NL3_16
    buffer_load_dwordx4 v[8:11], v84, s[24:27], 0 offen sc1
    buffer_load_dwordx4 v[14:17], v85, s[24:27], 0 offen sc1
    buffer_load_dwordx4 v[20:23], v86, s[24:27], 0 offen sc1
    buffer_load_dwordx4 v[26:29], v87, s[24:27], 0 offen sc1
L_NL3_16:
    ds_read_b128 v[84:87], v88 offset:48
    v_pk_fma_f32 v[90:91], v[88:89], s[62:63], v[2:3] op_sel:[1,0,0] op_sel_hi:[1,1,1]
    ds_read_b128 v[80:83], v90 offset:0
    v_pk_fma_f32 v[4:5], v[100:101], v[56:57], v[100:101]
    v_pk_fma_f32 v[6:7], v[102:103], v[58:59], v[102:103]
    v_pk_fma_f32 v[100:101], v[32:33], v[72:73], v[4:5]
    v_pk_fma_f32 v[102:103], v[96:97], v[74:75], v[6:7]
    v_pk_fma_f32 v[72:73], v[72:73], v[56:57], v[72:73]
    v_pk_fma_f32 v[74:75], v[74:75], v[58:59], v[74:75]
    v_pk_fma_f32 v[4:5], v[100:101], v[60:61], v[100:101]
    v_pk_fma_f32 v[6:7], v[102:103], v[62:63], v[102:103]
    v_pk_fma_f32 v[100:101], v[38:39], v[72:73], v[4:5]
    v_pk_fma_f32 v[102:103], v[98:99], v[74:75], v[6:7]
    v_pk_fma_f32 v[72:73], v[72:73], v[60:61], v[72:73]
    v_pk_fma_f32 v[74:75], v[74:75], v[62:63], v[74:75]
    v_pk_fma_f32 v[4:5], v[100:101], v[64:65], v[100:101]
    v_pk_fma_f32 v[6:7], v[102:103], v[66:67], v[102:103]
    v_pk_fma_f32 v[100:101], v[44:45], v[72:73], v[4:5]
    v_pk_fma_f32 v[102:103], v[104:105], v[74:75], v[6:7]
    v_pk_fma_f32 v[72:73], v[72:73], v[64:65], v[72:73]
    v_pk_fma_f32 v[74:75], v[74:75], v[66:67], v[74:75]
    v_pk_fma_f32 v[4:5], v[100:101], v[68:69], v[100:101]
    v_pk_fma_f32 v[6:7], v[102:103], v[70:71], v[102:103]
    v_pk_fma_f32 v[100:101], v[50:51], v[72:73], v[4:5]
    v_pk_fma_f32 v[102:103], v[124:125], v[74:75], v[6:7]
    v_pk_fma_f32 v[72:73], v[72:73], v[68:69], v[72:73]
    v_pk_fma_f32 v[74:75], v[74:75], v[70:71], v[74:75]
    v_pk_add_f32 v[4:5], v[72:73], v[74:75]
    v_add_f32 v106, v4, v5
    v_cmp_nge_f32 vcc, s64, v106
    s_cbranch_vccnz L_REDO1
L_RB1:
    v_pk_add_f32 v[94:95], v[94:95], s[60:61]
L_SB3:
    s_cmp_eq_u32 s50, 1
    s_waitcnt lgkmcnt(0)
    v_pk_add_f32 v[84:85], v[84:85], v[2:3] op_sel_hi:[1,0]
    v_pk_add_f32 v[86:87], v[86:87], v[2:3] op_sel_hi:[1,0]
    s_cbranch_scc1 L_LAST
L_M3:
    s_waitcnt vmcnt(2)
    v_mfma_f32_16x16x32_bf16 v[56:59], v[108:111], v[10:13], v[80:83]
    v_lshlrev_b64 v[96:97], 16, v[8:9]
    v_rcp_f32 v72, v72
    v_mfma_f32_16x16x32_bf16 v[60:63], v[112:115], v[16:19], v[80:83]
    v_lshlrev_b64 v[98:99], 16, v[14:15]
    v_rcp_f32 v73, v73
    s_waitcnt vmcnt(0)
    v_mfma_f32_16x16x32_bf16 v[64:67], v[116:119], v[22:25], v[80:83]
    v_lshlrev_b64 v[104:105], 16, v[20:21]
    v_rcp_f32 v74, v74
    v_mfma_f32_16x16x32_bf16 v[68:71], v[120:123], v[28:31], v[80:83]
    v_lshlrev_b64 v[124:125], 16, v[26:27]
    v_rcp_f32 v75, v75
    s_sub_u32 s50, s50, 1
    s_bitcmp1_b32 38, s50
    s_cbranch_scc1 L_PR3
    s_branch L_L0
L_PR3:
    s_setprio 2
    s_cmp_eq_u32 s50, 5
    s_cbranch_scc1 L_L0
    s_setprio 1
    s_cmp_eq_u32 s50, 2
    s_cbranch_scc1 L_L0
    s_setprio 0
    s_branch L_L0
L_PR0:
    s_setprio 2
    s_cmp_eq_u32 s50, 5
    s_cbranch_scc1 L_L1
    s_setprio 1
    s_cmp_eq_u32 s50, 2
    s_cbranch_scc1 L_L1
    s_setprio 0
    s_branch L_L1
L_PR1:
    s_setprio 2
    s_cmp_eq_u32 s50, 5
    s_cbranch_scc1 L_L2
    s_setprio 1
    s_cmp_eq_u32 s50, 2
    s_cbranch_scc1 L_L2
    s_setprio 0
    s_branch L_L2
L_PR2:
    s_setprio 2
    s_cmp_eq_u32 s50, 5
    s_cbranch_scc1 L_L3
    s_setprio 1
    s_cmp_eq_u32 s50, 2
    s_cbranch_scc1 L_L3
    s_setprio 0
    s_branch L_L3
L_CUT:
    v_pk_add_f32 v[4:5], v[72:73], v[74:75]
    v_add_f32 v106, v4, v5
    v_cmp_nge_f32 vcc, s64, v106
    s_cbranch_vccnz L_REDO0
L_RB0:
    v_mov_b32 v92, v91
L_LAST:
    v_rcp_f32 v72, v72
    v_rcp_f32 v73, v73
    v_rcp_f32 v74, v74
    v_rcp_f32 v75, v75
    s_nop 0
    v_pk_mul_f32 v[100:101], v[100:101], v[72:73]
    v_pk_mul_f32 v[102:103], v[102:103], v[74:75]
    v_cvt_f64_f32 v[76:77], v100
    v_cvt_f64_f32 v[78:79], v101
    v_cvt_f64_f32 v[4:5], v102
    v_cvt_f64_f32 v[6:7], v103
    ds_add_f64 v92, v[76:77] offset:0
    ds_add_f64 v92, v[78:79] offset:128
    ds_add_f64 v92, v[4:5] offset:256
    ds_add_f64 v92, v[6:7] offset:384
L_LD:
    s_cmp_lt_u32 s59, 10
    s_cbranch_scc0 L_LD2
    v_lshrrev_b32 v97, 3, v0
    v_and_b32 v98, 7, v0
    v_lshlrev_b32 v98, 4, v98
    s_mov_b32 s54, 528
    v_mad_u32_u24 v96, v97, s54, v98
    s_add_u32 s55, s101, s68
    v_cmp_gt_u32 s[80:81], s1, v97
    v_lshlrev_b32 v97, 8, v97
    v_add3_u32 v97, v97, v98, s55
    s_mov_b32 s56, s75
    s_mov_b32 s57, s75
L_LD2:
    s_waitcnt lgkmcnt(0)
    s_cmp_eq_u32 s58, 0
    s_barrier
    s_cbranch_scc0 L_MORE
    s_cmp_lt_u32 s59, 10
    s_cbranch_scc0 L_FIN
    ds_read_b128 v[24:27], v96 offset:21760
    ds_read_b128 v[28:31], v96 offset:21888
    ds_read_b128 v[32:35], v96 offset:22016
    ds_read_b128 v[36:39], v96 offset:22144
    s_waitcnt lgkmcnt(3)
    v_cvt_f32_f64 v8, v[24:25]
    v_cvt_f32_f64 v12, v[26:27]
    s_waitcnt lgkmcnt(2)
    v_cvt_f32_f64 v9, v[28:29]
    v_cvt_f32_f64 v13, v[30:31]
    s_waitcnt lgkmcnt(1)
    v_cvt_f32_f64 v10, v[32:33]
    v_cvt_f32_f64 v14, v[34:35]
    s_waitcnt lgkmcnt(0)
    v_cvt_f32_f64 v11, v[36:37]
    v_cvt_f32_f64 v15, v[38:39]
    v_pk_mul_f32 v[16:17], v[8:9], s[56:57]
    v_pk_mul_f32 v[18:19], v[10:11], s[56:57]
    v_pk_mul_f32 v[20:21], v[12:13], s[56:57]
    v_pk_mul_f32 v[22:23], v[14:15], s[56:57]
    v_exp_f32 v16, v16
    v_exp_f32 v17, v17
    v_exp_f32 v18, v18
    v_exp_f32 v19, v19
    v_exp_f32 v20, v20
    v_exp_f32 v21, v21
    v_exp_f32 v22, v22
    v_exp_f32 v23, v23
    v_pk_add_f32 v[16:17], v[16:17], 1.0 op_sel_hi:[1,0]
    v_pk_add_f32 v[18:19], v[18:19], 1.0 op_sel_hi:[1,0]
    v_pk_add_f32 v[20:21], v[20:21], 1.0 op_sel_hi:[1,0]
    v_pk_add_f32 v[22:23], v[22:23], 1.0 op_sel_hi:[1,0]
    v_rcp_f32 v16, v16
    v_rcp_f32 v17, v17
    v_rcp_f32 v18, v18
    v_rcp_f32 v19, v19
    v_rcp_f32 v20, v20
    v_rcp_f32 v21, v21
    v_rcp_f32 v22, v22
    v_rcp_f32 v23, v23
    v_pk_mul_f32 v[16:17], v[16:17], v[8:9]
    v_pk_mul_f32 v[18:19], v[18:19], v[10:11]
    v_pk_mul_f32 v[20:21], v[20:21], v[12:13]
    v_pk_mul_f32 v[22:23], v[22:23], v[14:15]
    v_cvt_pk_bf16_f32 v8, v16, v17
    v_cvt_pk_bf16_f32 v9, v18, v19
    v_cvt_pk_bf16_f32 v10, v20, v21
    v_cvt_pk_bf16_f32 v11, v22, v23
    s_mov_b64 exec, s[80:81]
    global_store_dwordx4 v97, v[8:11], s[18:19] sc1
L_FIN:
    s_endpgm
L_POLL2:
    s_sub_u32 s74, s74, 1
    s_cbranch_scc1 L_POLLX
    s_sleep 2
    buffer_load_dwordx2 v[88:89], v103, s[32:35], 0 offen sc1
    s_waitcnt vmcnt(0)
    s_branch L_POLL
L_POLLX:
    v_mov_b32 v88, 0
    s_mov_b32 s74, 0
    s_branch L_POLLED
L_EPO:
    v_mov_b32 v6, 11010048
    v_mov_b32 v7, s71
    s_mov_b64 exec, 1
    global_store_dword v6, v7, s[22:23] sc1
    s_mov_b64 exec, -1
    s_branch L_EPD
L_EG:
    v_mov_b32 v6, 0x100
    s_cmp_ge_u32 s59, 4
    s_cbranch_scc1 L_EG0
    s_mov_b32 exec_lo, -1
    s_mov_b32 exec_hi, 0
L_TP:
    s_waitcnt vmcnt(0)
    v_cmp_ne_u64 vcc, s[72:73], v[70:71]
    s_cbranch_vccz L_TRDY
    s_sub_u32 s74, s74, 1
    s_cbranch_scc1 L_END
    s_sleep 2
    global_load_dwordx2 v[70:71], v100, s[22:23] sc1
    s_branch L_TP
L_TRDY:
    s_mov_b64 exec, 1
    ds_add_u32 v124, v6 offset:8
    s_mul_i32 s56, s59, 640000
    s_lshr_b32 s57, s2, 3
    s_mul_i32 s57, s57, 19968
    s_add_u32 s56, s56, s57
    s_bfm_b64 exec, 16, 0
    v_lshlrev_b32 v5, 7, v1
    buffer_load_dword v106, v5, s[24:27], s56 offen sc1
L_EG0:
    s_mov_b64 exec, -1
L_EG1:
    s_sub_u32 s74, s74, 1
    s_cbranch_scc1 L_END
    ds_read_b32 v7, v124 offset:8
    ds_read_b32 v4, v94
    s_waitcnt lgkmcnt(0)
    ds_read_b128 v[60:63], v4
    v_readfirstlane_b32 s54, v7
    s_waitcnt lgkmcnt(0)
    v_or3_b32 v4, v60, v61, v62
    v_or_b32 v4, v4, v63
    v_cmp_le_u32 vcc, 4194304, v4
    s_and_b32 s55, s54, 0xff
    s_cmp_eq_u32 s55, 16
    s_cbranch_scc1 L_EGD
    s_cmp_lt_u32 s54, 0x400
    s_cbranch_scc1 L_EG1
    s_cbranch_vccnz L_EG1
    v_pk_add_f32 v[60:61], v[60:61], v[2:3] op_sel_hi:[1,0]
    v_pk_add_f32 v[62:63], v[62:63], v[2:3] op_sel_hi:[1,0]
    buffer_load_dwordx4 v[8:11], v60, s[24:27], 0 offen sc1
    buffer_load_dwordx4 v[14:17], v61, s[24:27], 0 offen sc1
    buffer_load_dwordx4 v[20:23], v62, s[24:27], 0 offen sc1
    buffer_load_dwordx4 v[26:29], v63, s[24:27], 0 offen sc1
    s_mov_b32 s0, 1
    s_branch L_EGD
L_FEW:
    s_mov_b32 s0, 0
    s_waitcnt vmcnt(0) lgkmcnt(0)
    v_min_u32 v96, 64, v96
    v_add_u32 v98, 15, v96
    v_lshrrev_b32 v96, 4, v96
    v_bfe_u32 v98, v98, 2, 2
    v_min_u32 v97, 64, v97
    v_add_u32 v99, 15, v97
    v_lshrrev_b32 v97, 4, v97
    v_bfe_u32 v99, v99, 2, 2
    s_mov_b32 s57, 192
    v_mad_u32_u24 v76, v96, s57, v76
    v_mad_u32_u24 v78, v97, s57, v78
    s_lshl3_add_u32 s56, s54, 131840
    v_cmp_eq_u32 s[80:81], 2, v98
    v_cmp_eq_u32 s[82:83], 2, v99
    v_cmp_eq_u32 s[84:85], 1, v98
    v_cmp_eq_u32 s[86:87], 1, v99
    v_cmp_eq_u32 s[88:89], 0, v98
    v_cmp_eq_u32 s[90:91], 0, v99
    s_mov_b32 s76, s56
    s_mov_b64 exec, s[80:81]
    v_mbcnt_lo_u32_b32 v96, exec_lo, 0
    v_mbcnt_hi_u32_b32 v96, exec_hi, v96
    v_lshl_add_u32 v96, v96, 3, s56
    s_bcnt1_i32_b64 s57, exec
    s_lshl3_add_u32 s56, s57, s56
    ds_write_b64 v96, v[76:77]
    s_mov_b64 exec, s[82:83]
    v_mbcnt_lo_u32_b32 v96, exec_lo, 0
    v_mbcnt_hi_u32_b32 v96, exec_hi, v96
    v_lshl_add_u32 v96, v96, 3, s56
    s_bcnt1_i32_b64 s57, exec
    s_lshl3_add_u32 s56, s57, s56
    ds_write_b64 v96, v[78:79]
    s_mov_b32 s77, s56
    s_mov_b64 exec, s[84:85]
    v_mbcnt_lo_u32_b32 v96, exec_lo, 0
    v_mbcnt_hi_u32_b32 v96, exec_hi, v96
    v_lshl_add_u32 v96, v96, 3, s56
    s_bcnt1_i32_b64 s57, exec
    s_lshl3_add_u32 s56, s57, s56
    ds_write_b64 v96, v[76:77]
    s_mov_b64 exec, s[86:87]
    v_mbcnt_lo_u32_b32 v96, exec_lo, 0
    v_mbcnt_hi_u32_b32 v96, exec_hi, v96
    v_lshl_add_u32 v96, v96, 3, s56
    s_bcnt1_i32_b64 s57, exec
    s_lshl3_add_u32 s56, s57, s56
    ds_write_b64 v96, v[78:79]
    s_mov_b32 s78, s56
    s_mov_b64 exec, s[88:89]
    v_mbcnt_lo_u32_b32 v96, exec_lo, 0
    v_mbcnt_hi_u32_b32 v96, exec_hi, v96
    v_lshl_add_u32 v96, v96, 3, s56
    s_bcnt1_i32_b64 s57, exec
    s_lshl3_add_u32 s56, s57, s56
    ds_write_b64 v96, v[76:77]
    s_mov_b64 exec, s[90:91]
    v_mbcnt_lo_u32_b32 v96, exec_lo, 0
    v_mbcnt_hi_u32_b32 v96, exec_hi, v96
    v_lshl_add_u32 v96, v96, 3, s56
    s_bcnt1_i32_b64 s57, exec
    s_lshl3_add_u32 s56, s57, s56
    ds_write_b64 v96, v[78:79]
    s_mov_b64 exec, -1
    s_sub_u32 s56, s56, 131816
    s_lshr_b32 s56, s56, 5
    s_sub_u32 s56, s56, s52
    s_add_u32 s56, s56, 15
    s_lshr_b32 s56, s56, 4
    s_lshl4_add_u32 s57, s56, s52
    s_lshl_b32 s57, s57, 5
    s_add_u32 s57, s57, 131328
    s_lshl2_add_u32 s50, s56, -2
    s_cmp_lt_u32 s57, s76
    s_addc_u32 s50, s50, 0
    s_cmp_lt_u32 s57, s77
    s_addc_u32 s50, s50, 0
    s_cmp_lt_u32 s57, s78
    s_addc_u32 s50, s50, 0
    s_cmp_eq_u32 s56, 0
    s_cbranch_scc1 L_LD
    v_mov_b32 v5, -1
    s_branch L_PRE
L_REDO0:
    s_mov_b32 s65, 0
    s_branch L_REDO
L_REDO1:
    s_mov_b32 s65, 1
L_REDO:
    ds_read_b64 v[76:77], v94
    ds_read_b32 v106, v95
    v_mov_b64 v[100:101], 0
    v_mov_b64 v[102:103], 0
    s_mov_b32 s54, 4
    s_waitcnt lgkmcnt(0)
    v_pk_fma_f32 v[78:79], v[76:77], s[62:63], v[2:3] op_sel:[1,0,0] op_sel_hi:[1,1,1]
    ds_read_b128 v[72:75], v78 offset:0
L_RD1:
    ds_read_b128 v[4:7], v76
    s_mov_b64 exec, s[66:67]
    ds_read_b64 v[110:111], v106 offset:16
    ds_read_b64 v[114:115], v106 offset:24
    ds_read_b64 v[118:119], v106 offset:32
    ds_read_b64 v[122:123], v106 offset:40
    s_mov_b64 exec, -1
    s_waitcnt lgkmcnt(0)
    v_pk_add_f32 v[4:5], v[4:5], v[2:3] op_sel_hi:[1,0]
    v_pk_add_f32 v[6:7], v[6:7], v[2:3] op_sel_hi:[1,0]
    buffer_load_dwordx4 v[32:35], v4, s[24:27], 0 offen sc1
    buffer_load_dwordx4 v[38:41], v5, s[24:27], 0 offen sc1
    buffer_load_dwordx4 v[44:47], v6, s[24:27], 0 offen sc1
    buffer_load_dwordx4 v[50:53], v7, s[24:27], 0 offen sc1
    v_add_u32 v76, 48, v76
    v_add_u32 v106, 48, v106
    s_waitcnt vmcnt(0)
    v_mfma_f32_16x16x32_bf16 v[56:59], v[108:111], v[34:37], v[72:75]
    v_mfma_f32_16x16x32_bf16 v[60:63], v[112:115], v[40:43], v[72:75]
    v_mfma_f32_16x16x32_bf16 v[64:67], v[116:119], v[46:49], v[72:75]
    v_mfma_f32_16x16x32_bf16 v[68:71], v[120:123], v[52:55], v[72:75]
    v_lshlrev_b64 v[96:97], 16, v[32:33]
    v_lshlrev_b64 v[98:99], 16, v[38:39]
    v_lshlrev_b64 v[104:105], 16, v[44:45]
    v_lshlrev_b64 v[124:125], 16, v[50:51]
    s_nop 3
    v_exp_f32 v56, v56
    v_exp_f32 v57, v57
    v_exp_f32 v58, v58
    v_exp_f32 v59, v59
    v_exp_f32 v60, v60
    v_exp_f32 v61, v61
    v_exp_f32 v62, v62
    v_exp_f32 v63, v63
    v_exp_f32 v64, v64
    v_exp_f32 v65, v65
    v_exp_f32 v66, v66
    v_exp_f32 v67, v67
    v_exp_f32 v68, v68
    v_exp_f32 v69, v69
    v_exp_f32 v70, v70
    v_exp_f32 v71, v71
    v_pk_add_f32 v[56:57], v[56:57], 1.0 op_sel_hi:[1,0]
    v_pk_add_f32 v[58:59], v[58:59], 1.0 op_sel_hi:[1,0]
    v_pk_add_f32 v[60:61], v[60:61], 1.0 op_sel_hi:[1,0]
    v_pk_add_f32 v[62:63], v[62:63], 1.0 op_sel_hi:[1,0]
    v_pk_add_f32 v[64:65], v[64:65], 1.0 op_sel_hi:[1,0]
    v_pk_add_f32 v[66:67], v[66:67], 1.0 op_sel_hi:[1,0]
    v_pk_add_f32 v[68:69], v[68:69], 1.0 op_sel_hi:[1,0]
    v_pk_add_f32 v[70:71], v[70:71], 1.0 op_sel_hi:[1,0]
    v_rcp_f32 v56, v56
    v_rcp_f32 v57, v57
    v_rcp_f32 v58, v58
    v_rcp_f32 v59, v59
    v_rcp_f32 v60, v60
    v_rcp_f32 v61, v61
    v_rcp_f32 v62, v62
    v_rcp_f32 v63, v63
    v_rcp_f32 v64, v64
    v_rcp_f32 v65, v65
    v_rcp_f32 v66, v66
    v_rcp_f32 v67, v67
    v_rcp_f32 v68, v68
    v_rcp_f32 v69, v69
    v_rcp_f32 v70, v70
    v_rcp_f32 v71, v71
    v_pk_fma_f32 v[100:101], v[56:57], v[32:33], v[100:101]
    v_pk_fma_f32 v[102:103], v[58:59], v[96:97], v[102:103]
    v_pk_fma_f32 v[100:101], v[60:61], v[38:39], v[100:101]
    v_pk_fma_f32 v[102:103], v[62:63], v[98:99], v[102:103]
    v_pk_fma_f32 v[100:101], v[64:65], v[44:45], v[100:101]
    v_pk_fma_f32 v[102:103], v[66:67], v[104:105], v[102:103]
    v_pk_fma_f32 v[100:101], v[68:69], v[50:51], v[100:101]
    v_pk_fma_f32 v[102:103], v[70:71], v[124:125], v[102:103]
    s_sub_u32 s54, s54, 1
    s_cmp_lg_u32 s54, 0
    s_cbranch_scc1 L_RD1
    s_mov_b64 exec, s[66:67]
    ds_read_b64 v[110:111], v93 offset:16
    ds_read_b64 v[114:115], v93 offset:24
    ds_read_b64 v[118:119], v93 offset:32
    ds_read_b64 v[122:123], v93 offset:40
    s_mov_b64 exec, -1
    v_mov_b32 v72, 1.0
    v_mov_b32 v73, 1.0
    v_mov_b32 v74, 1.0
    v_mov_b32 v75, 1.0
    s_cmp_eq_u32 s65, 0
    s_cbranch_scc1 L_RB0
    s_branch L_RB1
L_MORE:
    s_setprio 0
    s_mov_b32 s74, 4194304
    v_mov_b32 v124, 65024
    v_mov_b32 v125, 1
    v_lshlrev_b32 v4, 2, v0
    v_mov_b32 v5, 0
    v_cmp_gt_u32 vcc, 131, v0
    s_mov_b64 exec, vcc
    ds_write_b32 v4, v5 offset:64512
    s_mov_b64 exec, -1
    s_cmp_lt_u32 s59, 12
    s_cbranch_scc1 L_FILL
    s_branch L_FD
L_AGAIN:
    s_cmp_eq_u32 s51, 0
    s_cbranch_scc0 L_LOADS
    v_subrev_u32 v127, 28, v127
    v_add_u32 v126, 336, v126
    s_branch L_WINDOW
L_END:
    s_endpgm
.section .rodata,"a"
.p2align 6
.amdhsa_kernel standalone__edge_featured_mpnn_egc__graph_kernel
  .amdhsa_next_free_vgpr 128
  .amdhsa_next_free_sgpr 102
  .amdhsa_accum_offset 128
  .amdhsa_group_segment_fixed_size 0
  .amdhsa_kernarg_size 80
  .amdhsa_user_sgpr_count 2
  .amdhsa_user_sgpr_kernarg_segment_ptr 1
  .amdhsa_system_sgpr_workgroup_id_x 1
  .amdhsa_float_denorm_mode_32 3
.end_amdhsa_kernel
```
